```python
import torch

def _softmax(x, axis=-1):
    return torch.softmax(x, dim=axis)
def _gelu(x):
    return torch.nn.functional.gelu(x, approximate="tanh")
def _silu(x):
    return torch.nn.functional.silu(x)
def _sigmoid(x):
    return torch.sigmoid(x)
def _layernorm(x, axis=-1, eps=1e-5):
    m = x.mean(dim=axis, keepdim=True)
    v = x.var(dim=axis, keepdim=True, unbiased=False)
    return (x - m) / torch.sqrt(v + eps)
def _scatter_add(tgt, idx, src, axis=0):
    return tgt.clone().index_add_(axis, idx, src)
def _segment_sum(src, seg, n):
    out = torch.zeros((n,) + src.shape[1:], dtype=src.dtype)
    return out.index_add_(0, seg, src)
def _pad(x, pw):
    flat = tuple(v for pair in reversed(pw) for v in pair)
    return torch.nn.functional.pad(x, flat)

kernel_name = 'standalone__glu_gated_reglu__prompt'

def setup_inputs():

    _w = (lambda a: (lambda t: t.to(torch.bfloat16) if t.is_floating_point() else t)(torch.as_tensor(a)))
    B, S, D, F = 1, 2048, 640, 1536
    return {
        "x": _w((lambda *s: torch.randn(*s, dtype=torch.bfloat16) * 0.05)(B, S, D)),
        "W_gate": _w((lambda *s: torch.randn(*s, dtype=torch.bfloat16) * 0.05)(D, F) * (2.0 / D) ** 0.5),
        "W_up": _w((lambda *s: torch.randn(*s, dtype=torch.bfloat16) * 0.05)(D, F) * (2.0 / D) ** 0.5),
        "W_down": _w((lambda *s: torch.randn(*s, dtype=torch.bfloat16) * 0.05)(F, D) * (1.0 / F) ** 0.5),
    }

def reference(x, W_gate, W_up, W_down):
    gate = torch.einsum("bsd,df->bsf", x, W_gate)
    up = torch.einsum("bsd,df->bsf", x, W_up)
    gate = gate * (lambda x, dt: x.to(dt))(gate > 0, gate.dtype)
    h = gate * up
    return torch.einsum("bsf,fd->bsd", h, W_down)
```

```asm
; @launch grid=(256,1,1) block=(256,1,1) lds=163840
.amdgcn_target "amdgcn-amd-amdhsa--gfx950"
.text
.globl standalone__glu_gated_reglu__prompt_kernel
.p2align 8
.type standalone__glu_gated_reglu__prompt_kernel,@function
standalone__glu_gated_reglu__prompt_kernel:
    s_cmp_ge_u32 s2, 256
    s_cbranch_scc1 L_done
    s_load_dwordx2 s[4:5], s[0:1], 0
    s_load_dwordx2 s[8:9], s[0:1], 8
    s_load_dwordx2 s[12:13], s[0:1], 16
    s_getpc_b64 s[82:83]
L_pc:
    s_bfe_u32 s47, s2, 0x20003
    s_mul_i32 s47, s47, 32
    v_add_lshl_u32 v2, v0, s47, 7
    v_min_u32 v2, L_end - L_pc - 4, v2
    v_mov_b32 v3, 0
    v_lshl_add_u64 v[2:3], v[2:3], 0, s[82:83]
    v_cmp_gt_u32 vcc, 32, v0
    s_and_saveexec_b64 s[86:87], vcc
    s_cbranch_execz L_nocp
    global_load_dword v5, v[2:3], off
L_nocp:
    s_mov_b64 exec, -1
    v_lshrrev_b32 v1, 6, v0
    v_and_b32 v0, 63, v0
    v_readfirstlane_b32 s32, v1
    s_lshr_b32 s33, s2, 4
    s_and_b32 s47, s2, 7
    s_lshl_b32 s49, s47, 2
    s_bitcmp1_b32 s2, 3
    s_mov_b32 s34, 0xdca87420
    s_cselect_b32 s34, 0xfeb96531, s34
    s_cselect_b32 s48, 0x11551615, 0
    s_lshr_b32 s34, s34, s49
    s_and_b32 s34, s34, 15
    s_lshr_b32 s48, s48, s49
    s_and_b32 s48, s48, 15
    s_mul_i32 s48, s48, 1
    s_add_u32 s47, s33, s47
    s_add_u32 s47, s47, s48
    s_mul_i32 s48, s47, 6554
    s_lshr_b32 s48, s48, 16
    s_mul_i32 s48, s48, 10
    s_sub_u32 s47, s47, s48
    s_mul_i32 s37, s47, 128
    v_lshrrev_b32 v2, 3, v0
    v_mul_u32_u24 v3, 1280, v2
    v_lshrrev_b32 v4, 4, v0
    v_and_b32 v1, 7, v0
    v_xor_b32 v4, v4, v1
    v_lshl_add_u32 v40, v4, 4, v3
    v_xor_b32 v41, 64, v40
    v_add_u32 v41, 9216, v41
    v_add_u32 v42, 18432, v40
    v_add_u32 v43, 18432, v41
    s_lshl2_add_u32 s47, s33, s32
    s_mov_b32 s6, 40960
    s_mul_i32 s47, s47, s6
    s_mov_b32 s7, 0x262144
    s_lshl_b32 s39, s32, 12
    s_mov_b32 m0, s39
    s_waitcnt lgkmcnt(0)
    s_add_u32 s4, s4, s47
    s_addc_u32 s5, s5, 0
    buffer_load_dwordx4 v40, s[4:7], s37 offen offset:0 lds
    buffer_load_dwordx4 v41, s[4:7], s37 offen offset:1024 lds
    buffer_load_dwordx4 v42, s[4:7], s37 offen offset:2048 lds
    buffer_load_dwordx4 v43, s[4:7], s37 offen offset:3072 lds
    s_load_dwordx2 s[16:17], s[0:1], 24
    s_load_dwordx2 s[20:21], s[0:1], 32
    s_load_dwordx2 s[28:29], s[0:1], 40
    s_load_dwordx2 s[24:25], s[0:1], 48
    s_cmp_lt_u32 s32, 2
    s_cselect_b32 s8, s8, s12
    s_cselect_b32 s9, s9, s13
    s_and_b32 s49, s32, 1
    s_mul_i32 s47, s49, 49152
    s_mul_i32 s48, s34, 192
    s_add_u32 s48, s48, s47
    s_add_u32 s8, s8, s48
    s_addc_u32 s9, s9, 0
    s_sub_u32 s10, 1966080, s48
    s_mov_b32 s11, 0x262144
    s_mul_i32 s38, s37, 1536
    s_add_u32 s44, s38, 98304
    s_lshr_b32 s48, s32, 1
    s_lshl2_add_u32 s40, s48, s49
    s_mul_i32 s40, s40, 3072
    s_movk_i32 s47, 2880
    v_lshlrev_b32 v6, 4, v0
    v_mul_u32_u24 v2, 5462, v0
    v_lshrrev_b32 v3, 16, v2
    v_lshrrev_b32 v4, 14, v2
    v_and_b32 v4, 32, v4
    v_xor_b32 v4, v4, v6
    v_mad_u32_u24 v44, v3, s47, v4
    v_add_u32 v2, 349568, v2
    v_lshrrev_b32 v3, 16, v2
    v_lshrrev_b32 v4, 14, v2
    v_and_b32 v4, 32, v4
    v_xor_b32 v4, v4, v6
    v_mad_u32_u24 v45, v3, s47, v4
    v_add_u32 v2, 349568, v2
    v_lshrrev_b32 v3, 16, v2
    v_lshrrev_b32 v4, 14, v2
    v_and_b32 v4, 32, v4
    v_xor_b32 v4, v4, v6
    v_mad_u32_u24 v46, v3, s47, v4
    s_add_u32 m0, s40, 16384
    s_nop 0
    buffer_load_dwordx4 v44, s[8:11], s38 offen offset:0 lds
    buffer_load_dwordx4 v45, s[8:11], s38 offen offset:1024 lds
    buffer_load_dwordx4 v46, s[8:11], s38 offen offset:2048 lds
    s_add_u32 m0, s40, 22528
    s_nop 0
    buffer_load_dwordx4 v44, s[8:11], s44 offen offset:0 lds
    buffer_load_dwordx4 v45, s[8:11], s44 offen offset:1024 lds
    buffer_load_dwordx4 v46, s[8:11], s44 offen offset:2048 lds
    s_mov_b32 s26, 33554432
    s_mov_b32 s27, 0x262144
    s_mov_b32 s30, 256
    s_mov_b32 s31, 0x262144
    s_lshl_b32 s47, s33, 11
    s_add_u32 s47, s47, 10354688
    s_lshl_b32 s48, s33, 2
    s_mov_b32 s49, s34
    s_or_b32 s49, s49, s32
    s_cmp_eq_u32 s49, 0
    s_cselect_b32 s47, s47, s26
    s_cselect_b32 s48, s48, s30
    v_lshrrev_b32 v2, 3, v0
    v_lshlrev_b32 v2, 25, v2
    v_and_b32 v3, 7, v0
    v_lshl_add_u32 v2, v3, 8, v2
    v_lshl_add_u32 v24, v0, 8, s48
    v_mov_b32 v3, 0
    v_mov_b32 v13, 1
    v_mov_b32 v58, 1
    s_waitcnt lgkmcnt(0)
    s_mov_b64 exec, 255
    buffer_store_dword v3, v2, s[24:27], s47 offen sc1
    s_mov_b64 exec, -1
    s_add_u32 s37, s37, 128
    s_cmpk_eq_u32 s37, 1280
    s_cselect_b32 s37, 0, s37
    s_mul_i32 s38, s37, 1536
    s_add_u32 s44, s38, 98304
    v_and_b32 v2, 15, v0
    v_lshlrev_b32 v8, 2, v2
    s_lshr_b32 s47, s32, 1
    s_lshl_b32 s47, s47, 13
    v_lshlrev_b32 v3, 7, v2
    v_add_u32 v3, s47, v3
    v_bfe_u32 v4, v0, 1, 3
    v_lshrrev_b32 v1, 4, v0
    v_xor_b32 v4, v4, v1
    v_lshl_add_u32 v32, v4, 4, v3
    v_xor_b32 v33, 64, v32
    v_bfe_u32 v4, v0, 2, 2
    v_lshl_add_u32 v3, v1, 3, v4
    v_mul_u32_u24 v3, 192, v3
    v_and_b32 v4, 3, v0
    v_lshl_add_u32 v3, v4, 3, v3
    v_add_u32 v3, 16384, v3
    v_and_b32 v2, 1, v1
    s_and_b32 s47, s32, 1
    s_mul_i32 s47, s47, 3
    s_add_u32 s48, s47, 0
    v_xor_b32 v4, s48, v2
    v_lshl_add_u32 v34, v4, 5, v3
    s_add_u32 s48, s47, 1
    v_xor_b32 v4, s48, v2
    v_lshl_add_u32 v35, v4, 5, v3
    s_add_u32 s48, s47, 2
    v_xor_b32 v4, s48, v2
    v_lshl_add_u32 v36, v4, 5, v3
    v_add_u32 v48, 81920, v32
    v_add_u32 v49, 81920, v33
    v_add_u32 v50, 81920, v34
    v_add_u32 v51, 81920, v35
    v_add_u32 v52, 81920, v36
    s_mul_i32 s47, s2, 13108
    s_lshr_b32 s46, s47, 16
    s_mul_i32 s48, s46, 5
    s_sub_u32 s48, s2, s48
    s_mov_b32 s18, 1966080
    s_mov_b32 s19, 0x262144
    v_lshrrev_b32 v2, 4, v0
    v_bfe_u32 v3, v0, 1, 3
    v_xor_b32 v3, v3, v2
    s_and_b32 s47, s32, 1
    s_lshl_b32 s47, s47, 2
    v_xor_b32 v3, s47, v3
    v_and_b32 v4, 1, v0
    v_lshlrev_b32 v4, 4, v4
    v_mul_u32_u24 v2, 1280, v2
    v_add_u32 v2, v2, v4
    v_lshl_add_u32 v9, v3, 5, v2
    s_lshl2_add_u32 s47, s46, s32
    s_mul_i32 s47, s47, 10240
    s_lshl_b32 s49, s48, 8
    s_add_u32 s47, s47, s49
    v_add_u32 v9, s47, v9
    v_add_u32 v10, 4096, v9
    s_bfe_u32 s42, s2, 0x10005
    s_lshl_b32 s41, s32, 11
    s_add_u32 s41, s41, 122880
    s_lshl_b32 s48, s48, 3
    s_mul_i32 s47, s46, 5462
    s_lshr_b32 s47, s47, 16
    s_add_u32 s47, s47, s48
    s_lshl_b32 s47, s47, 8
    s_add_u32 s47, s47, 10355712
    s_cmp_eq_u32 s32, 0
    s_cselect_b32 s47, s47, s26
    s_cmp_lt_u32 s2, 240
    s_cselect_b32 s47, s47, s26
    v_lshl_add_u32 v25, v0, 25, s47
    s_lshl_b32 s49, s32, 1
    s_add_u32 s48, s48, s49
    s_mul_i32 s46, s46, 5
    s_add_u32 s47, s48, 0
    s_mul_i32 s61, s47, 13108
    s_lshr_b32 s61, s61, 16
    s_mul_i32 s61, s61, 235
    s_add_u32 s61, s61, s47
    s_add_u32 s61, s61, s46
    s_lshl_b32 s61, s61, 10
    s_add_u32 s61, s61, 8388608
    s_cmp_lt_u32 s2, 240
    s_cselect_b32 s61, s61, s26
    s_add_u32 s47, s48, 1
    s_mul_i32 s62, s47, 13108
    s_lshr_b32 s62, s62, 16
    s_mul_i32 s62, s62, 235
    s_add_u32 s62, s62, s47
    s_add_u32 s62, s62, s46
    s_lshl_b32 s62, s62, 10
    s_add_u32 s62, s62, 8388608
    s_cmp_lt_u32 s2, 240
    s_cselect_b32 s62, s62, s26
    v_bfe_u32 v2, v0, 4, 1
    v_bfe_u32 v3, v0, 2, 2
    v_lshl_add_u32 v2, v2, 2, v3
    v_lshrrev_b32 v4, 4, v0
    v_lshl_add_u32 v3, v4, 3, v3
    v_lshlrev_b32 v3, 8, v3
    v_and_b32 v4, 3, v0
    v_lshl_add_u32 v3, v4, 3, v3
    v_add_u32 v3, 122880, v3
    v_xor_b32 v2, s49, v2
    v_lshl_add_u32 v11, v2, 5, v3
    v_xor_b32 v12, 32, v11
    s_and_b32 s47, s2, 6
    s_lshr_b32 s48, s2, 5
    s_lshl2_add_u32 s35, s47, s48
    s_and_b32 s47, s2, 1
    s_bfe_u32 s36, s2, 0x20003
    s_lshl2_add_u32 s36, s47, s36
    s_mul_i32 s55, s32, 10240
    s_lshl2_add_u32 s47, s36, s32
    s_mul_i32 s47, s47, 61440
    s_add_u32 s78, s47, 8388608
    v_add_u32 v7, 4096, v6
    v_and_b32 v2, 1, v0
    s_mul_i32 s47, s36, 5
    v_lshl_add_u32 v2, v2, 2, s47
    v_and_b32 v2, 0x38, v2
    s_add_u32 s47, s32, 40452
    v_add_lshl_u32 v59, v2, s47, 8
    s_mov_b32 s22, 2621440
    s_mov_b32 s23, 0x262144
    s_lshl2_add_u32 s47, s35, s32
    s_mul_i32 s48, s47, 49152
    s_mul_i32 s49, s35, 26
    s_lshr_b32 s49, s49, 8
    s_lshl_b32 s49, s49, 17
    s_add_u32 s48, s48, s49
    v_add_u32 v2, s48, v6
    s_mul_i32 s47, s47, 20480
    s_mul_i32 s48, s36, 160
    s_add_u32 s56, s47, s48
    s_add_u32 s47, s32, 1
    s_and_b32 s47, s47, 3
    s_lshl_b32 s47, s47, 10
    v_add_u32 v60, s47, v2
    s_add_u32 s47, s32, 2
    s_and_b32 s47, s47, 3
    s_lshl_b32 s47, s47, 10
    v_add_u32 v61, s47, v2
    s_add_u32 s47, s32, 3
    s_and_b32 s47, s47, 3
    s_lshl_b32 s47, s47, 10
    v_add_u32 v62, s47, v2
    s_add_u32 s47, s32, 4
    s_and_b32 s47, s47, 3
    s_lshl_b32 s47, s47, 10
    v_add_u32 v63, s47, v2
    s_lshr_b32 s48, s34, 2
    s_lshl3_add_u32 s47, s33, s48
    s_lshl_b32 s47, s47, 8
    s_add_u32 s47, s47, 10354688
    s_cmp_eq_u32 s32, 0
    s_cselect_b32 s47, s47, s26
    v_lshl_add_u32 v26, v0, 25, s47
    s_lshr_b32 s47, s35, 1
    s_lshl3_add_u32 s47, s47, s32
    s_lshl_b32 s47, s47, 8
    s_add_u32 s58, s47, 10354688
    v_bfe_u32 v2, v0, 4, 1
    v_lshlrev_b32 v2, 10, v2
    v_lshrrev_b32 v3, 5, v0
    v_lshl_add_u32 v2, v3, 8, v2
    v_and_b32 v3, 15, v0
    v_lshl_add_u32 v57, v3, 4, v2
    s_lshr_b32 s47, s32, 1
    s_lshl1_add_u32 s47, s33, s47
    s_mul_i32 s49, s47, 26
    s_lshr_b32 s49, s49, 8
    s_lshl_b32 s49, s49, 17
    s_mul_i32 s47, s47, 196608
    s_add_u32 s47, s47, s49
    s_and_b32 s48, s32, 1
    s_lshl1_add_u32 s48, s34, s48
    s_mul_i32 s48, s48, 3
    s_add_u32 s49, s48, 0
    s_and_b32 s50, s49, 1
    s_mul_i32 s50, s50, -1536
    s_lshl_b32 s49, s49, 11
    s_add_u32 s50, s50, s49
    s_add_u32 s50, s50, s47
    s_add_u32 s49, s48, 1
    s_and_b32 s51, s49, 1
    s_mul_i32 s51, s51, -1536
    s_lshl_b32 s49, s49, 11
    s_add_u32 s51, s51, s49
    s_add_u32 s51, s51, s47
    s_add_u32 s49, s48, 2
    s_and_b32 s52, s49, 1
    s_mul_i32 s52, s52, -1536
    s_lshl_b32 s49, s49, 11
    s_add_u32 s52, s52, s49
    s_add_u32 s52, s52, s47
    s_mov_b32 s64, 0
    s_mov_b32 s65, 4096
    s_mov_b32 s66, 8192
    s_mov_b32 s67, 12288
    s_mov_b32 s68, 16384
    s_mov_b32 s69, 20480
    s_mov_b32 s70, 24576
    s_mov_b32 s71, 28672
    s_mov_b32 s72, 32768
    s_mov_b32 s73, 36864
    s_mov_b32 s74, 40960
    s_mov_b32 s75, 45056
    s_add_u32 m0, s39, 40960
    s_nop 0
    buffer_load_dwordx4 v40, s[4:7], s37 offen offset:0 lds
    buffer_load_dwordx4 v41, s[4:7], s37 offen offset:1024 lds
    buffer_load_dwordx4 v42, s[4:7], s37 offen offset:2048 lds
    buffer_load_dwordx4 v43, s[4:7], s37 offen offset:3072 lds
    s_add_u32 m0, s40, 57344
    s_nop 0
    buffer_load_dwordx4 v44, s[8:11], s38 offen offset:0 lds
    buffer_load_dwordx4 v45, s[8:11], s38 offen offset:1024 lds
    buffer_load_dwordx4 v46, s[8:11], s38 offen offset:2048 lds
    s_add_u32 m0, s40, 63488
    s_nop 0
    buffer_load_dwordx4 v44, s[8:11], s44 offen offset:0 lds
    buffer_load_dwordx4 v45, s[8:11], s44 offen offset:1024 lds
    buffer_load_dwordx4 v46, s[8:11], s44 offen offset:2048 lds
    s_add_u32 s37, s37, 128
    s_cmpk_eq_u32 s37, 1280
    s_cselect_b32 s37, 0, s37
    s_mul_i32 s38, s37, 1536
    s_add_u32 s44, s38, 98304
    s_waitcnt vmcnt(10)
    s_barrier
    s_mov_b64 exec, 1
    buffer_store_dword v13, v24, s[28:31], 0 offen sc1
    s_mov_b64 exec, -1
    ds_read_b128 v[96:99], v32 offset:0
    ds_read_b64_tr_b16 v[64:65], v34 offset:0
    ds_read_b64_tr_b16 v[66:67], v34 offset:768
    ds_read_b128 v[112:115], v33 offset:0
    ds_read_b64_tr_b16 v[68:69], v34 offset:6144
    ds_read_b64_tr_b16 v[70:71], v34 offset:6912
    ds_read_b128 v[116:119], v33 offset:2048
    ds_read_b128 v[100:103], v32 offset:2048
    ds_read_b128 v[104:107], v32 offset:4096
    ds_read_b128 v[120:123], v33 offset:4096
    ds_read_b128 v[124:127], v33 offset:6144
    s_add_u32 m0, s39, 81920
    s_nop 0
    buffer_load_dwordx4 v40, s[4:7], s37 offen offset:0 lds
    buffer_load_dwordx4 v41, s[4:7], s37 offen offset:1024 lds
    s_waitcnt lgkmcnt(5)
    v_mfma_f32_16x16x32_bf16 v[160:163], v[64:67], v[96:99], 0
    ds_read_b128 v[108:111], v32 offset:6144
    v_mfma_f32_16x16x32_bf16 v[160:163], v[68:71], v[112:115], v[160:163]
    ds_read_b64_tr_b16 v[72:73], v34 offset:12288
    s_waitcnt lgkmcnt(5)
    v_mfma_f32_16x16x32_bf16 v[164:167], v[68:71], v[116:119], 0
    ds_read_b64_tr_b16 v[74:75], v34 offset:13056
    buffer_load_dwordx4 v42, s[4:7], s37 offen offset:2048 lds
    v_mfma_f32_16x16x32_bf16 v[164:167], v[64:67], v[100:103], v[164:167]
    ds_read_b64_tr_b16 v[76:77], v34 offset:18432
    s_waitcnt lgkmcnt(5)
    v_mfma_f32_16x16x32_bf16 v[168:171], v[64:67], v[104:107], 0
    ds_read_b64_tr_b16 v[78:79], v34 offset:19200
    v_mfma_f32_16x16x32_bf16 v[168:171], v[68:71], v[120:123], v[168:171]
    ds_read_b64_tr_b16 v[80:81], v35 offset:0
    s_waitcnt lgkmcnt(5)
    v_mfma_f32_16x16x32_bf16 v[172:175], v[68:71], v[124:127], 0
    ds_read_b64_tr_b16 v[82:83], v35 offset:768
    v_mfma_f32_16x16x32_bf16 v[172:175], v[64:67], v[108:111], v[172:175]
    ds_read_b64_tr_b16 v[84:85], v35 offset:6144
    buffer_load_dwordx4 v43, s[4:7], s37 offen offset:3072 lds
    s_waitcnt lgkmcnt(5)
    v_mfma_f32_16x16x32_bf16 v[188:191], v[72:75], v[108:111], 0
    ds_read_b64_tr_b16 v[86:87], v35 offset:6912
    s_waitcnt lgkmcnt(4)
    v_mfma_f32_16x16x32_bf16 v[188:191], v[76:79], v[124:127], v[188:191]
    ds_read_b64_tr_b16 v[88:89], v35 offset:12288
    v_mfma_f32_16x16x32_bf16 v[184:187], v[76:79], v[120:123], 0
    ds_read_b64_tr_b16 v[90:91], v35 offset:13056
    v_mfma_f32_16x16x32_bf16 v[184:187], v[72:75], v[104:107], v[184:187]
    ds_read_b64_tr_b16 v[92:93], v35 offset:18432
    s_add_u32 m0, s40, 98304
    v_mfma_f32_16x16x32_bf16 v[180:183], v[72:75], v[100:103], 0
    ds_read_b64_tr_b16 v[94:95], v35 offset:19200
    buffer_load_dwordx4 v44, s[8:11], s38 offen offset:0 lds
    v_mfma_f32_16x16x32_bf16 v[180:183], v[76:79], v[116:119], v[180:183]
    v_mfma_f32_16x16x32_bf16 v[176:179], v[76:79], v[112:115], 0
    ds_read_b64_tr_b16 v[64:65], v36 offset:0
    v_mfma_f32_16x16x32_bf16 v[176:179], v[72:75], v[96:99], v[176:179]
    ds_read_b64_tr_b16 v[66:67], v36 offset:768
    s_waitcnt lgkmcnt(6)
    v_mfma_f32_16x16x32_bf16 v[192:195], v[80:83], v[96:99], 0
    ds_read_b64_tr_b16 v[68:69], v36 offset:6144
    buffer_load_dwordx4 v45, s[8:11], s38 offen offset:1024 lds
    v_mfma_f32_16x16x32_bf16 v[192:195], v[84:87], v[112:115], v[192:195]
    ds_read_b64_tr_b16 v[70:71], v36 offset:6912
    v_mfma_f32_16x16x32_bf16 v[196:199], v[84:87], v[116:119], 0
    ds_read_b64_tr_b16 v[72:73], v36 offset:12288
    v_mfma_f32_16x16x32_bf16 v[196:199], v[80:83], v[100:103], v[196:199]
    ds_read_b64_tr_b16 v[74:75], v36 offset:13056
    v_mfma_f32_16x16x32_bf16 v[200:203], v[80:83], v[104:107], 0
    ds_read_b64_tr_b16 v[76:77], v36 offset:18432
    v_mfma_f32_16x16x32_bf16 v[200:203], v[84:87], v[120:123], v[200:203]
    ds_read_b64_tr_b16 v[78:79], v36 offset:19200
    buffer_load_dwordx4 v46, s[8:11], s38 offen offset:2048 lds
    v_mfma_f32_16x16x32_bf16 v[204:207], v[84:87], v[124:127], 0
    v_mfma_f32_16x16x32_bf16 v[204:207], v[80:83], v[108:111], v[204:207]
    s_waitcnt lgkmcnt(4)
    v_mfma_f32_16x16x32_bf16 v[220:223], v[88:91], v[108:111], 0
    s_add_u32 m0, s40, 104448
    v_mfma_f32_16x16x32_bf16 v[220:223], v[92:95], v[124:127], v[220:223]
    buffer_load_dwordx4 v44, s[8:11], s44 offen offset:0 lds
    v_mfma_f32_16x16x32_bf16 v[216:219], v[92:95], v[120:123], 0
    v_mfma_f32_16x16x32_bf16 v[216:219], v[88:91], v[104:107], v[216:219]
    v_mfma_f32_16x16x32_bf16 v[212:215], v[88:91], v[100:103], 0
    v_mfma_f32_16x16x32_bf16 v[212:215], v[92:95], v[116:119], v[212:215]
    buffer_load_dwordx4 v45, s[8:11], s44 offen offset:1024 lds
    v_mfma_f32_16x16x32_bf16 v[208:211], v[92:95], v[112:115], 0
    v_mfma_f32_16x16x32_bf16 v[208:211], v[88:91], v[96:99], v[208:211]
    v_mfma_f32_16x16x32_bf16 v[224:227], v[64:67], v[96:99], 0
    v_mfma_f32_16x16x32_bf16 v[224:227], v[68:71], v[112:115], v[224:227]
    buffer_load_dwordx4 v46, s[8:11], s44 offen offset:2048 lds
    v_mfma_f32_16x16x32_bf16 v[228:231], v[68:71], v[116:119], 0
    s_add_u32 s37, s37, 128
    s_cmpk_eq_u32 s37, 1280
    v_mfma_f32_16x16x32_bf16 v[228:231], v[64:67], v[100:103], v[228:231]
    s_cselect_b32 s37, 0, s37
    s_mul_i32 s38, s37, 1536
    v_mfma_f32_16x16x32_bf16 v[232:235], v[64:67], v[104:107], 0
    s_add_u32 s44, s38, 98304
    v_mfma_f32_16x16x32_bf16 v[232:235], v[68:71], v[120:123], v[232:235]
    s_waitcnt vmcnt(11) lgkmcnt(0)
    s_barrier
    s_mov_b32 m0, s41
    s_nop 0
    buffer_load_dwordx4 v9, s[16:19], 0 offen  lds
    buffer_load_dwordx4 v10, s[16:19], 0 offen offset:1024  lds
    ds_read_b128 v[128:131], v32 offset:40960
    v_mfma_f32_16x16x32_bf16 v[236:239], v[68:71], v[124:127], 0
    ds_read_b64_tr_b16 v[80:81], v34 offset:40960
    v_mfma_f32_16x16x32_bf16 v[236:239], v[64:67], v[108:111], v[236:239]
    ds_read_b64_tr_b16 v[82:83], v34 offset:41728
    s_add_u32 m0, s39, 0
    v_mfma_f32_16x16x32_bf16 v[252:255], v[72:75], v[108:111], 0
    ds_read_b128 v[144:147], v33 offset:40960
    buffer_load_dwordx4 v40, s[4:7], s37 offen offset:0 lds
    v_mfma_f32_16x16x32_bf16 v[252:255], v[76:79], v[124:127], v[252:255]
    ds_read_b64_tr_b16 v[84:85], v34 offset:47104
    v_mfma_f32_16x16x32_bf16 v[248:251], v[76:79], v[120:123], 0
    ds_read_b64_tr_b16 v[86:87], v34 offset:47872
    v_mfma_f32_16x16x32_bf16 v[248:251], v[72:75], v[104:107], v[248:251]
    ds_read_b128 v[148:151], v33 offset:43008
    v_mfma_f32_16x16x32_bf16 v[244:247], v[72:75], v[100:103], 0
    ds_read_b128 v[132:135], v32 offset:43008
    v_mfma_f32_16x16x32_bf16 v[244:247], v[76:79], v[116:119], v[244:247]
    ds_read_b128 v[136:139], v32 offset:45056
    buffer_load_dwordx4 v41, s[4:7], s37 offen offset:1024 lds
    v_mfma_f32_16x16x32_bf16 v[240:243], v[76:79], v[112:115], 0
    ds_read_b128 v[152:155], v33 offset:45056
    v_mfma_f32_16x16x32_bf16 v[240:243], v[72:75], v[96:99], v[240:243]
    ds_read_b128 v[156:159], v33 offset:47104
    s_waitcnt lgkmcnt(5)
    v_mfma_f32_16x16x32_bf16 v[160:163], v[80:83], v[128:131], v[160:163]
    ds_read_b128 v[140:143], v32 offset:47104
    v_mfma_f32_16x16x32_bf16 v[160:163], v[84:87], v[144:147], v[160:163]
    ds_read_b64_tr_b16 v[88:89], v34 offset:53248
    s_waitcnt lgkmcnt(5)
    v_mfma_f32_16x16x32_bf16 v[164:167], v[84:87], v[148:151], v[164:167]
    ds_read_b64_tr_b16 v[90:91], v34 offset:54016
    buffer_load_dwordx4 v42, s[4:7], s37 offen offset:2048 lds
    v_mfma_f32_16x16x32_bf16 v[164:167], v[80:83], v[132:135], v[164:167]
    ds_read_b64_tr_b16 v[92:93], v34 offset:59392
    s_waitcnt lgkmcnt(5)
    v_mfma_f32_16x16x32_bf16 v[168:171], v[80:83], v[136:139], v[168:171]
    ds_read_b64_tr_b16 v[94:95], v34 offset:60160
    v_mfma_f32_16x16x32_bf16 v[168:171], v[84:87], v[152:155], v[168:171]
    ds_read_b64_tr_b16 v[64:65], v35 offset:40960
    s_waitcnt lgkmcnt(5)
    v_mfma_f32_16x16x32_bf16 v[172:175], v[84:87], v[156:159], v[172:175]
    ds_read_b64_tr_b16 v[66:67], v35 offset:41728
    v_mfma_f32_16x16x32_bf16 v[172:175], v[80:83], v[140:143], v[172:175]
    ds_read_b64_tr_b16 v[68:69], v35 offset:47104
    buffer_load_dwordx4 v43, s[4:7], s37 offen offset:3072 lds
    s_waitcnt lgkmcnt(5)
    v_mfma_f32_16x16x32_bf16 v[188:191], v[88:91], v[140:143], v[188:191]
    ds_read_b64_tr_b16 v[70:71], v35 offset:47872
    s_waitcnt lgkmcnt(4)
    v_mfma_f32_16x16x32_bf16 v[188:191], v[92:95], v[156:159], v[188:191]
    ds_read_b64_tr_b16 v[72:73], v35 offset:53248
    v_mfma_f32_16x16x32_bf16 v[184:187], v[92:95], v[152:155], v[184:187]
    ds_read_b64_tr_b16 v[74:75], v35 offset:54016
    v_mfma_f32_16x16x32_bf16 v[184:187], v[88:91], v[136:139], v[184:187]
    ds_read_b64_tr_b16 v[76:77], v35 offset:59392
    s_add_u32 m0, s40, 16384
    v_mfma_f32_16x16x32_bf16 v[180:183], v[88:91], v[132:135], v[180:183]
    ds_read_b64_tr_b16 v[78:79], v35 offset:60160
    buffer_load_dwordx4 v44, s[8:11], s38 offen offset:0 lds
    v_mfma_f32_16x16x32_bf16 v[180:183], v[92:95], v[148:151], v[180:183]
    v_mfma_f32_16x16x32_bf16 v[176:179], v[92:95], v[144:147], v[176:179]
    ds_read_b64_tr_b16 v[80:81], v36 offset:40960
    v_mfma_f32_16x16x32_bf16 v[176:179], v[88:91], v[128:131], v[176:179]
    ds_read_b64_tr_b16 v[82:83], v36 offset:41728
    s_waitcnt lgkmcnt(6)
    v_mfma_f32_16x16x32_bf16 v[192:195], v[64:67], v[128:131], v[192:195]
    ds_read_b64_tr_b16 v[84:85], v36 offset:47104
    buffer_load_dwordx4 v45, s[8:11], s38 offen offset:1024 lds
    v_mfma_f32_16x16x32_bf16 v[192:195], v[68:71], v[144:147], v[192:195]
    ds_read_b64_tr_b16 v[86:87], v36 offset:47872
    v_mfma_f32_16x16x32_bf16 v[196:199], v[68:71], v[148:151], v[196:199]
    ds_read_b64_tr_b16 v[88:89], v36 offset:53248
    v_mfma_f32_16x16x32_bf16 v[196:199], v[64:67], v[132:135], v[196:199]
    ds_read_b64_tr_b16 v[90:91], v36 offset:54016
    v_mfma_f32_16x16x32_bf16 v[200:203], v[64:67], v[136:139], v[200:203]
    ds_read_b64_tr_b16 v[92:93], v36 offset:59392
    v_mfma_f32_16x16x32_bf16 v[200:203], v[68:71], v[152:155], v[200:203]
    ds_read_b64_tr_b16 v[94:95], v36 offset:60160
    buffer_load_dwordx4 v46, s[8:11], s38 offen offset:2048 lds
    v_mfma_f32_16x16x32_bf16 v[204:207], v[68:71], v[156:159], v[204:207]
    v_mfma_f32_16x16x32_bf16 v[204:207], v[64:67], v[140:143], v[204:207]
    s_waitcnt lgkmcnt(4)
    v_mfma_f32_16x16x32_bf16 v[220:223], v[72:75], v[140:143], v[220:223]
    s_add_u32 m0, s40, 22528
    v_mfma_f32_16x16x32_bf16 v[220:223], v[76:79], v[156:159], v[220:223]
    buffer_load_dwordx4 v44, s[8:11], s44 offen offset:0 lds
    v_mfma_f32_16x16x32_bf16 v[216:219], v[76:79], v[152:155], v[216:219]
    v_mfma_f32_16x16x32_bf16 v[216:219], v[72:75], v[136:139], v[216:219]
    v_mfma_f32_16x16x32_bf16 v[212:215], v[72:75], v[132:135], v[212:215]
    v_mfma_f32_16x16x32_bf16 v[212:215], v[76:79], v[148:151], v[212:215]
    buffer_load_dwordx4 v45, s[8:11], s44 offen offset:1024 lds
    v_mfma_f32_16x16x32_bf16 v[208:211], v[76:79], v[144:147], v[208:211]
    v_mfma_f32_16x16x32_bf16 v[208:211], v[72:75], v[128:131], v[208:211]
    v_mfma_f32_16x16x32_bf16 v[224:227], v[80:83], v[128:131], v[224:227]
    v_mfma_f32_16x16x32_bf16 v[224:227], v[84:87], v[144:147], v[224:227]
    buffer_load_dwordx4 v46, s[8:11], s44 offen offset:2048 lds
    v_mfma_f32_16x16x32_bf16 v[228:231], v[84:87], v[148:151], v[228:231]
    s_add_u32 s37, s37, 128
    s_cmpk_eq_u32 s37, 1280
    v_mfma_f32_16x16x32_bf16 v[228:231], v[80:83], v[132:135], v[228:231]
    s_cselect_b32 s37, 0, s37
    s_mul_i32 s38, s37, 1536
    v_mfma_f32_16x16x32_bf16 v[232:235], v[80:83], v[136:139], v[232:235]
    s_add_u32 s44, s38, 98304
    v_mfma_f32_16x16x32_bf16 v[232:235], v[84:87], v[152:155], v[232:235]
    s_waitcnt vmcnt(10) lgkmcnt(0)
    s_barrier
    ds_read_b64_tr_b16 v[16:17], v11 offset:0
    ds_read_b64_tr_b16 v[18:19], v11 offset:1024
    ds_read_b64_tr_b16 v[20:21], v12 offset:0
    ds_read_b64_tr_b16 v[22:23], v12 offset:1024
    ds_read_b128 v[96:99], v48 offset:0
    v_mfma_f32_16x16x32_bf16 v[236:239], v[84:87], v[156:159], v[236:239]
    ds_read_b64_tr_b16 v[64:65], v50 offset:0
    buffer_load_dword v58, v8, s[28:31], 0 offen sc1
    v_mfma_f32_16x16x32_bf16 v[236:239], v[80:83], v[140:143], v[236:239]
    ds_read_b64_tr_b16 v[66:67], v50 offset:768
    s_add_u32 m0, s39, 40960
    v_mfma_f32_16x16x32_bf16 v[252:255], v[88:91], v[140:143], v[252:255]
    ds_read_b128 v[112:115], v49 offset:0
    buffer_load_dwordx4 v40, s[4:7], s37 offen offset:0 lds
    v_mfma_f32_16x16x32_bf16 v[252:255], v[92:95], v[156:159], v[252:255]
    ds_read_b64_tr_b16 v[68:69], v50 offset:6144
    v_mfma_f32_16x16x32_bf16 v[248:251], v[92:95], v[152:155], v[248:251]
    ds_read_b64_tr_b16 v[70:71], v50 offset:6912
    v_mfma_f32_16x16x32_bf16 v[248:251], v[88:91], v[136:139], v[248:251]
    ds_read_b128 v[116:119], v49 offset:2048
    v_mfma_f32_16x16x32_bf16 v[244:247], v[88:91], v[132:135], v[244:247]
    ds_read_b128 v[100:103], v48 offset:2048
    v_mfma_f32_16x16x32_bf16 v[244:247], v[92:95], v[148:151], v[244:247]
    ds_read_b128 v[104:107], v48 offset:4096
    buffer_load_dwordx4 v41, s[4:7], s37 offen offset:1024 lds
    v_mfma_f32_16x16x32_bf16 v[240:243], v[92:95], v[144:147], v[240:243]
    ds_read_b128 v[120:123], v49 offset:4096
    v_mfma_f32_16x16x32_bf16 v[240:243], v[88:91], v[128:131], v[240:243]
    ds_read_b128 v[124:127], v49 offset:6144
    s_waitcnt lgkmcnt(5)
    v_mfma_f32_16x16x32_bf16 v[160:163], v[64:67], v[96:99], v[160:163]
    ds_read_b128 v[108:111], v48 offset:6144
    v_mfma_f32_16x16x32_bf16 v[160:163], v[68:71], v[112:115], v[160:163]
    ds_read_b64_tr_b16 v[72:73], v50 offset:12288
    s_waitcnt lgkmcnt(5)
    v_mfma_f32_16x16x32_bf16 v[164:167], v[68:71], v[116:119], v[164:167]
    ds_read_b64_tr_b16 v[74:75], v50 offset:13056
    buffer_load_dwordx4 v42, s[4:7], s37 offen offset:2048 lds
    v_mfma_f32_16x16x32_bf16 v[164:167], v[64:67], v[100:103], v[164:167]
    ds_read_b64_tr_b16 v[76:77], v50 offset:18432
    s_waitcnt lgkmcnt(5)
    v_mfma_f32_16x16x32_bf16 v[168:171], v[64:67], v[104:107], v[168:171]
    ds_read_b64_tr_b16 v[78:79], v50 offset:19200
    v_mfma_f32_16x16x32_bf16 v[168:171], v[68:71], v[120:123], v[168:171]
    ds_read_b64_tr_b16 v[80:81], v51 offset:0
    s_waitcnt lgkmcnt(5)
    v_mfma_f32_16x16x32_bf16 v[172:175], v[68:71], v[124:127], v[172:175]
    ds_read_b64_tr_b16 v[82:83], v51 offset:768
    v_mfma_f32_16x16x32_bf16 v[172:175], v[64:67], v[108:111], v[172:175]
    ds_read_b64_tr_b16 v[84:85], v51 offset:6144
    buffer_load_dwordx4 v43, s[4:7], s37 offen offset:3072 lds
    s_waitcnt lgkmcnt(5)
    v_mfma_f32_16x16x32_bf16 v[188:191], v[72:75], v[108:111], v[188:191]
    ds_read_b64_tr_b16 v[86:87], v51 offset:6912
    s_waitcnt lgkmcnt(4)
    v_mfma_f32_16x16x32_bf16 v[188:191], v[76:79], v[124:127], v[188:191]
    ds_read_b64_tr_b16 v[88:89], v51 offset:12288
    v_mfma_f32_16x16x32_bf16 v[184:187], v[76:79], v[120:123], v[184:187]
    ds_read_b64_tr_b16 v[90:91], v51 offset:13056
    v_mfma_f32_16x16x32_bf16 v[184:187], v[72:75], v[104:107], v[184:187]
    ds_read_b64_tr_b16 v[92:93], v51 offset:18432
    s_add_u32 m0, s40, 57344
    v_mfma_f32_16x16x32_bf16 v[180:183], v[72:75], v[100:103], v[180:183]
    ds_read_b64_tr_b16 v[94:95], v51 offset:19200
    buffer_load_dwordx4 v44, s[8:11], s38 offen offset:0 lds
    v_mfma_f32_16x16x32_bf16 v[180:183], v[76:79], v[116:119], v[180:183]
    v_mfma_f32_16x16x32_bf16 v[176:179], v[76:79], v[112:115], v[176:179]
    ds_read_b64_tr_b16 v[64:65], v52 offset:0
    v_mfma_f32_16x16x32_bf16 v[176:179], v[72:75], v[96:99], v[176:179]
    ds_read_b64_tr_b16 v[66:67], v52 offset:768
    s_waitcnt lgkmcnt(6)
    v_mfma_f32_16x16x32_bf16 v[192:195], v[80:83], v[96:99], v[192:195]
    ds_read_b64_tr_b16 v[68:69], v52 offset:6144
    buffer_load_dwordx4 v45, s[8:11], s38 offen offset:1024 lds
    v_mfma_f32_16x16x32_bf16 v[192:195], v[84:87], v[112:115], v[192:195]
    ds_read_b64_tr_b16 v[70:71], v52 offset:6912
    v_mfma_f32_16x16x32_bf16 v[196:199], v[84:87], v[116:119], v[196:199]
    ds_read_b64_tr_b16 v[72:73], v52 offset:12288
    v_mfma_f32_16x16x32_bf16 v[196:199], v[80:83], v[100:103], v[196:199]
    ds_read_b64_tr_b16 v[74:75], v52 offset:13056
    v_mfma_f32_16x16x32_bf16 v[200:203], v[80:83], v[104:107], v[200:203]
    ds_read_b64_tr_b16 v[76:77], v52 offset:18432
    v_mfma_f32_16x16x32_bf16 v[200:203], v[84:87], v[120:123], v[200:203]
    ds_read_b64_tr_b16 v[78:79], v52 offset:19200
    buffer_load_dwordx4 v46, s[8:11], s38 offen offset:2048 lds
    v_mfma_f32_16x16x32_bf16 v[204:207], v[84:87], v[124:127], v[204:207]
    v_mfma_f32_16x16x32_bf16 v[204:207], v[80:83], v[108:111], v[204:207]
    s_waitcnt lgkmcnt(4)
    v_mfma_f32_16x16x32_bf16 v[220:223], v[88:91], v[108:111], v[220:223]
    s_add_u32 m0, s40, 63488
    v_mfma_f32_16x16x32_bf16 v[220:223], v[92:95], v[124:127], v[220:223]
    buffer_load_dwordx4 v44, s[8:11], s44 offen offset:0 lds
    v_mfma_f32_16x16x32_bf16 v[216:219], v[92:95], v[120:123], v[216:219]
    v_mfma_f32_16x16x32_bf16 v[216:219], v[88:91], v[104:107], v[216:219]
    v_mfma_f32_16x16x32_bf16 v[212:215], v[88:91], v[100:103], v[212:215]
    v_mfma_f32_16x16x32_bf16 v[212:215], v[92:95], v[116:119], v[212:215]
    buffer_load_dwordx4 v45, s[8:11], s44 offen offset:1024 lds
    v_mfma_f32_16x16x32_bf16 v[208:211], v[92:95], v[112:115], v[208:211]
    v_mfma_f32_16x16x32_bf16 v[208:211], v[88:91], v[96:99], v[208:211]
    v_mfma_f32_16x16x32_bf16 v[224:227], v[64:67], v[96:99], v[224:227]
    v_mfma_f32_16x16x32_bf16 v[224:227], v[68:71], v[112:115], v[224:227]
    buffer_load_dwordx4 v46, s[8:11], s44 offen offset:2048 lds
    v_mfma_f32_16x16x32_bf16 v[228:231], v[68:71], v[116:119], v[228:231]
    s_add_u32 s37, s37, 128
    s_cmpk_eq_u32 s37, 1280
    v_mfma_f32_16x16x32_bf16 v[228:231], v[64:67], v[100:103], v[228:231]
    s_cselect_b32 s37, 0, s37
    s_mul_i32 s38, s37, 1536
    v_mfma_f32_16x16x32_bf16 v[232:235], v[64:67], v[104:107], v[232:235]
    s_add_u32 s44, s38, 98304
    buffer_store_dwordx4 v[16:19], v6, s[24:27], s61 offen sc1
    v_mfma_f32_16x16x32_bf16 v[232:235], v[68:71], v[120:123], v[232:235]
    buffer_store_dwordx4 v[20:23], v6, s[24:27], s62 offen sc1
    s_waitcnt vmcnt(13) lgkmcnt(0)
    s_barrier
    ds_read_b128 v[128:131], v32 offset:0
    v_mfma_f32_16x16x32_bf16 v[236:239], v[68:71], v[124:127], v[236:239]
    ds_read_b64_tr_b16 v[80:81], v34 offset:0
    v_mfma_f32_16x16x32_bf16 v[236:239], v[64:67], v[108:111], v[236:239]
    ds_read_b64_tr_b16 v[82:83], v34 offset:768
    s_add_u32 m0, s39, 81920
    v_mfma_f32_16x16x32_bf16 v[252:255], v[72:75], v[108:111], v[252:255]
    ds_read_b128 v[144:147], v33 offset:0
    buffer_load_dwordx4 v40, s[4:7], s37 offen offset:0 lds
    v_mfma_f32_16x16x32_bf16 v[252:255], v[76:79], v[124:127], v[252:255]
    ds_read_b64_tr_b16 v[84:85], v34 offset:6144
    v_mfma_f32_16x16x32_bf16 v[248:251], v[76:79], v[120:123], v[248:251]
    ds_read_b64_tr_b16 v[86:87], v34 offset:6912
    v_mfma_f32_16x16x32_bf16 v[248:251], v[72:75], v[104:107], v[248:251]
    ds_read_b128 v[148:151], v33 offset:2048
    v_mfma_f32_16x16x32_bf16 v[244:247], v[72:75], v[100:103], v[244:247]
    ds_read_b128 v[132:135], v32 offset:2048
    v_mfma_f32_16x16x32_bf16 v[244:247], v[76:79], v[116:119], v[244:247]
    ds_read_b128 v[136:139], v32 offset:4096
    buffer_load_dwordx4 v41, s[4:7], s37 offen offset:1024 lds
    v_mfma_f32_16x16x32_bf16 v[240:243], v[76:79], v[112:115], v[240:243]
    ds_read_b128 v[152:155], v33 offset:4096
    v_mfma_f32_16x16x32_bf16 v[240:243], v[72:75], v[96:99], v[240:243]
    ds_read_b128 v[156:159], v33 offset:6144
    s_waitcnt lgkmcnt(5)
    v_mfma_f32_16x16x32_bf16 v[160:163], v[80:83], v[128:131], v[160:163]
    ds_read_b128 v[140:143], v32 offset:6144
    v_mfma_f32_16x16x32_bf16 v[160:163], v[84:87], v[144:147], v[160:163]
    ds_read_b64_tr_b16 v[88:89], v34 offset:12288
    s_waitcnt lgkmcnt(5)
    v_mfma_f32_16x16x32_bf16 v[164:167], v[84:87], v[148:151], v[164:167]
    ds_read_b64_tr_b16 v[90:91], v34 offset:13056
    buffer_load_dwordx4 v42, s[4:7], s37 offen offset:2048 lds
    v_mfma_f32_16x16x32_bf16 v[164:167], v[80:83], v[132:135], v[164:167]
    ds_read_b64_tr_b16 v[92:93], v34 offset:18432
    s_waitcnt lgkmcnt(5)
    v_mfma_f32_16x16x32_bf16 v[168:171], v[80:83], v[136:139], v[168:171]
    ds_read_b64_tr_b16 v[94:95], v34 offset:19200
    v_mfma_f32_16x16x32_bf16 v[168:171], v[84:87], v[152:155], v[168:171]
    ds_read_b64_tr_b16 v[64:65], v35 offset:0
    s_waitcnt lgkmcnt(5)
    v_mfma_f32_16x16x32_bf16 v[172:175], v[84:87], v[156:159], v[172:175]
    ds_read_b64_tr_b16 v[66:67], v35 offset:768
    v_mfma_f32_16x16x32_bf16 v[172:175], v[80:83], v[140:143], v[172:175]
    ds_read_b64_tr_b16 v[68:69], v35 offset:6144
    buffer_load_dwordx4 v43, s[4:7], s37 offen offset:3072 lds
    s_waitcnt lgkmcnt(5)
    v_mfma_f32_16x16x32_bf16 v[188:191], v[88:91], v[140:143], v[188:191]
    ds_read_b64_tr_b16 v[70:71], v35 offset:6912
    s_waitcnt lgkmcnt(4)
    v_mfma_f32_16x16x32_bf16 v[188:191], v[92:95], v[156:159], v[188:191]
    ds_read_b64_tr_b16 v[72:73], v35 offset:12288
    v_mfma_f32_16x16x32_bf16 v[184:187], v[92:95], v[152:155], v[184:187]
    ds_read_b64_tr_b16 v[74:75], v35 offset:13056
    v_mfma_f32_16x16x32_bf16 v[184:187], v[88:91], v[136:139], v[184:187]
    ds_read_b64_tr_b16 v[76:77], v35 offset:18432
    s_add_u32 m0, s40, 98304
    v_mfma_f32_16x16x32_bf16 v[180:183], v[88:91], v[132:135], v[180:183]
    ds_read_b64_tr_b16 v[78:79], v35 offset:19200
    buffer_load_dwordx4 v44, s[8:11], s38 offen offset:0 lds
    v_mfma_f32_16x16x32_bf16 v[180:183], v[92:95], v[148:151], v[180:183]
    v_mfma_f32_16x16x32_bf16 v[176:179], v[92:95], v[144:147], v[176:179]
    ds_read_b64_tr_b16 v[80:81], v36 offset:0
    v_mfma_f32_16x16x32_bf16 v[176:179], v[88:91], v[128:131], v[176:179]
    ds_read_b64_tr_b16 v[82:83], v36 offset:768
    s_waitcnt lgkmcnt(6)
    v_mfma_f32_16x16x32_bf16 v[192:195], v[64:67], v[128:131], v[192:195]
    ds_read_b64_tr_b16 v[84:85], v36 offset:6144
    buffer_load_dwordx4 v45, s[8:11], s38 offen offset:1024 lds
    v_mfma_f32_16x16x32_bf16 v[192:195], v[68:71], v[144:147], v[192:195]
    ds_read_b64_tr_b16 v[86:87], v36 offset:6912
    v_mfma_f32_16x16x32_bf16 v[196:199], v[68:71], v[148:151], v[196:199]
    ds_read_b64_tr_b16 v[88:89], v36 offset:12288
    v_mfma_f32_16x16x32_bf16 v[196:199], v[64:67], v[132:135], v[196:199]
    ds_read_b64_tr_b16 v[90:91], v36 offset:13056
    v_mfma_f32_16x16x32_bf16 v[200:203], v[64:67], v[136:139], v[200:203]
    ds_read_b64_tr_b16 v[92:93], v36 offset:18432
    v_mfma_f32_16x16x32_bf16 v[200:203], v[68:71], v[152:155], v[200:203]
    ds_read_b64_tr_b16 v[94:95], v36 offset:19200
    buffer_load_dwordx4 v46, s[8:11], s38 offen offset:2048 lds
    v_mfma_f32_16x16x32_bf16 v[204:207], v[68:71], v[156:159], v[204:207]
    v_mfma_f32_16x16x32_bf16 v[204:207], v[64:67], v[140:143], v[204:207]
    s_waitcnt lgkmcnt(4)
    v_mfma_f32_16x16x32_bf16 v[220:223], v[72:75], v[140:143], v[220:223]
    s_add_u32 m0, s40, 104448
    v_mfma_f32_16x16x32_bf16 v[220:223], v[76:79], v[156:159], v[220:223]
    buffer_load_dwordx4 v44, s[8:11], s44 offen offset:0 lds
    v_mfma_f32_16x16x32_bf16 v[216:219], v[76:79], v[152:155], v[216:219]
    v_mfma_f32_16x16x32_bf16 v[216:219], v[72:75], v[136:139], v[216:219]
    v_mfma_f32_16x16x32_bf16 v[212:215], v[72:75], v[132:135], v[212:215]
    v_mfma_f32_16x16x32_bf16 v[212:215], v[76:79], v[148:151], v[212:215]
    buffer_load_dwordx4 v45, s[8:11], s44 offen offset:1024 lds
    v_mfma_f32_16x16x32_bf16 v[208:211], v[76:79], v[144:147], v[208:211]
    v_mfma_f32_16x16x32_bf16 v[208:211], v[72:75], v[128:131], v[208:211]
    v_mfma_f32_16x16x32_bf16 v[224:227], v[80:83], v[128:131], v[224:227]
    v_mfma_f32_16x16x32_bf16 v[224:227], v[84:87], v[144:147], v[224:227]
    buffer_load_dwordx4 v46, s[8:11], s44 offen offset:2048 lds
    v_mfma_f32_16x16x32_bf16 v[228:231], v[84:87], v[148:151], v[228:231]
    s_add_u32 s37, s37, 128
    s_cmpk_eq_u32 s37, 1280
    v_mfma_f32_16x16x32_bf16 v[228:231], v[80:83], v[132:135], v[228:231]
    s_cselect_b32 s37, 0, s37
    s_mul_i32 s38, s37, 1536
    v_mfma_f32_16x16x32_bf16 v[232:235], v[80:83], v[136:139], v[232:235]
    s_add_u32 s44, s38, 98304
    v_mfma_f32_16x16x32_bf16 v[232:235], v[84:87], v[152:155], v[232:235]
    s_waitcnt vmcnt(10) lgkmcnt(0)
    s_barrier
    v_cmp_ne_u32 vcc, 1, v58
    s_cbranch_vccnz L_zchk
L_zchk_ok:
    ds_read_b128 v[96:99], v32 offset:40960
    v_mfma_f32_16x16x32_bf16 v[236:239], v[84:87], v[156:159], v[236:239]
    ds_read_b64_tr_b16 v[64:65], v34 offset:40960
    s_mov_b64 exec, 1
    buffer_atomic_add v13, v25, s[24:27], 0 offen sc1
    s_mov_b64 exec, -1
    v_mfma_f32_16x16x32_bf16 v[236:239], v[80:83], v[140:143], v[236:239]
    ds_read_b64_tr_b16 v[66:67], v34 offset:41728
    s_add_u32 m0, s39, 0
    v_mfma_f32_16x16x32_bf16 v[252:255], v[88:91], v[140:143], v[252:255]
    ds_read_b128 v[112:115], v33 offset:40960
    buffer_load_dwordx4 v40, s[4:7], s37 offen offset:0 lds
    v_mfma_f32_16x16x32_bf16 v[252:255], v[92:95], v[156:159], v[252:255]
    ds_read_b64_tr_b16 v[68:69], v34 offset:47104
    v_mfma_f32_16x16x32_bf16 v[248:251], v[92:95], v[152:155], v[248:251]
    ds_read_b64_tr_b16 v[70:71], v34 offset:47872
    v_mfma_f32_16x16x32_bf16 v[248:251], v[88:91], v[136:139], v[248:251]
    ds_read_b128 v[116:119], v33 offset:43008
    v_mfma_f32_16x16x32_bf16 v[244:247], v[88:91], v[132:135], v[244:247]
    ds_read_b128 v[100:103], v32 offset:43008
    v_mfma_f32_16x16x32_bf16 v[244:247], v[92:95], v[148:151], v[244:247]
    ds_read_b128 v[104:107], v32 offset:45056
    buffer_load_dwordx4 v41, s[4:7], s37 offen offset:1024 lds
    v_mfma_f32_16x16x32_bf16 v[240:243], v[92:95], v[144:147], v[240:243]
    ds_read_b128 v[120:123], v33 offset:45056
    v_mfma_f32_16x16x32_bf16 v[240:243], v[88:91], v[128:131], v[240:243]
    ds_read_b128 v[124:127], v33 offset:47104
    s_waitcnt lgkmcnt(5)
    v_mfma_f32_16x16x32_bf16 v[160:163], v[64:67], v[96:99], v[160:163]
    ds_read_b128 v[108:111], v32 offset:47104
    v_mfma_f32_16x16x32_bf16 v[160:163], v[68:71], v[112:115], v[160:163]
    ds_read_b64_tr_b16 v[72:73], v34 offset:53248
    s_waitcnt lgkmcnt(5)
    v_mfma_f32_16x16x32_bf16 v[164:167], v[68:71], v[116:119], v[164:167]
    ds_read_b64_tr_b16 v[74:75], v34 offset:54016
    buffer_load_dwordx4 v42, s[4:7], s37 offen offset:2048 lds
    v_mfma_f32_16x16x32_bf16 v[164:167], v[64:67], v[100:103], v[164:167]
    ds_read_b64_tr_b16 v[76:77], v34 offset:59392
    s_waitcnt lgkmcnt(5)
    v_mfma_f32_16x16x32_bf16 v[168:171], v[64:67], v[104:107], v[168:171]
    ds_read_b64_tr_b16 v[78:79], v34 offset:60160
    v_mfma_f32_16x16x32_bf16 v[168:171], v[68:71], v[120:123], v[168:171]
    ds_read_b64_tr_b16 v[80:81], v35 offset:40960
    s_waitcnt lgkmcnt(5)
    v_mfma_f32_16x16x32_bf16 v[172:175], v[68:71], v[124:127], v[172:175]
    ds_read_b64_tr_b16 v[82:83], v35 offset:41728
    v_mfma_f32_16x16x32_bf16 v[172:175], v[64:67], v[108:111], v[172:175]
    ds_read_b64_tr_b16 v[84:85], v35 offset:47104
    buffer_load_dwordx4 v43, s[4:7], s37 offen offset:3072 lds
    s_waitcnt lgkmcnt(5)
    v_mfma_f32_16x16x32_bf16 v[188:191], v[72:75], v[108:111], v[188:191]
    ds_read_b64_tr_b16 v[86:87], v35 offset:47872
    s_waitcnt lgkmcnt(4)
    v_mfma_f32_16x16x32_bf16 v[188:191], v[76:79], v[124:127], v[188:191]
    ds_read_b64_tr_b16 v[88:89], v35 offset:53248
    v_mfma_f32_16x16x32_bf16 v[184:187], v[76:79], v[120:123], v[184:187]
    ds_read_b64_tr_b16 v[90:91], v35 offset:54016
    v_mfma_f32_16x16x32_bf16 v[184:187], v[72:75], v[104:107], v[184:187]
    ds_read_b64_tr_b16 v[92:93], v35 offset:59392
    s_add_u32 m0, s40, 16384
    v_mfma_f32_16x16x32_bf16 v[180:183], v[72:75], v[100:103], v[180:183]
    ds_read_b64_tr_b16 v[94:95], v35 offset:60160
    buffer_load_dwordx4 v44, s[8:11], s38 offen offset:0 lds
    v_mfma_f32_16x16x32_bf16 v[180:183], v[76:79], v[116:119], v[180:183]
    v_mfma_f32_16x16x32_bf16 v[176:179], v[76:79], v[112:115], v[176:179]
    ds_read_b64_tr_b16 v[64:65], v36 offset:40960
    v_mfma_f32_16x16x32_bf16 v[176:179], v[72:75], v[96:99], v[176:179]
    ds_read_b64_tr_b16 v[66:67], v36 offset:41728
    s_waitcnt lgkmcnt(6)
    v_mfma_f32_16x16x32_bf16 v[192:195], v[80:83], v[96:99], v[192:195]
    ds_read_b64_tr_b16 v[68:69], v36 offset:47104
    buffer_load_dwordx4 v45, s[8:11], s38 offen offset:1024 lds
    v_mfma_f32_16x16x32_bf16 v[192:195], v[84:87], v[112:115], v[192:195]
    ds_read_b64_tr_b16 v[70:71], v36 offset:47872
    v_mfma_f32_16x16x32_bf16 v[196:199], v[84:87], v[116:119], v[196:199]
    ds_read_b64_tr_b16 v[72:73], v36 offset:53248
    v_mfma_f32_16x16x32_bf16 v[196:199], v[80:83], v[100:103], v[196:199]
    ds_read_b64_tr_b16 v[74:75], v36 offset:54016
    v_mfma_f32_16x16x32_bf16 v[200:203], v[80:83], v[104:107], v[200:203]
    ds_read_b64_tr_b16 v[76:77], v36 offset:59392
    v_mfma_f32_16x16x32_bf16 v[200:203], v[84:87], v[120:123], v[200:203]
    ds_read_b64_tr_b16 v[78:79], v36 offset:60160
    buffer_load_dwordx4 v46, s[8:11], s38 offen offset:2048 lds
    v_mfma_f32_16x16x32_bf16 v[204:207], v[84:87], v[124:127], v[204:207]
    v_mfma_f32_16x16x32_bf16 v[204:207], v[80:83], v[108:111], v[204:207]
    s_waitcnt lgkmcnt(4)
    v_mfma_f32_16x16x32_bf16 v[220:223], v[88:91], v[108:111], v[220:223]
    s_add_u32 m0, s40, 22528
    v_mfma_f32_16x16x32_bf16 v[220:223], v[92:95], v[124:127], v[220:223]
    buffer_load_dwordx4 v44, s[8:11], s44 offen offset:0 lds
    v_mfma_f32_16x16x32_bf16 v[216:219], v[92:95], v[120:123], v[216:219]
    v_mfma_f32_16x16x32_bf16 v[216:219], v[88:91], v[104:107], v[216:219]
    v_mfma_f32_16x16x32_bf16 v[212:215], v[88:91], v[100:103], v[212:215]
    v_mfma_f32_16x16x32_bf16 v[212:215], v[92:95], v[116:119], v[212:215]
    buffer_load_dwordx4 v45, s[8:11], s44 offen offset:1024 lds
    v_mfma_f32_16x16x32_bf16 v[208:211], v[92:95], v[112:115], v[208:211]
    v_mfma_f32_16x16x32_bf16 v[208:211], v[88:91], v[96:99], v[208:211]
    v_mfma_f32_16x16x32_bf16 v[224:227], v[64:67], v[96:99], v[224:227]
    v_mfma_f32_16x16x32_bf16 v[224:227], v[68:71], v[112:115], v[224:227]
    buffer_load_dwordx4 v46, s[8:11], s44 offen offset:2048 lds
    v_mfma_f32_16x16x32_bf16 v[228:231], v[68:71], v[116:119], v[228:231]
    s_add_u32 s37, s37, 128
    s_cmpk_eq_u32 s37, 1280
    v_mfma_f32_16x16x32_bf16 v[228:231], v[64:67], v[100:103], v[228:231]
    s_cselect_b32 s37, 0, s37
    s_mul_i32 s38, s37, 1536
    v_mfma_f32_16x16x32_bf16 v[232:235], v[64:67], v[104:107], v[232:235]
    s_add_u32 s44, s38, 98304
    v_mfma_f32_16x16x32_bf16 v[232:235], v[68:71], v[120:123], v[232:235]
    s_waitcnt vmcnt(11) lgkmcnt(0)
    s_barrier
    ds_read_b128 v[128:131], v48 offset:0
    v_mfma_f32_16x16x32_bf16 v[236:239], v[68:71], v[124:127], v[236:239]
    ds_read_b64_tr_b16 v[80:81], v50 offset:0
    v_mfma_f32_16x16x32_bf16 v[236:239], v[64:67], v[108:111], v[236:239]
    ds_read_b64_tr_b16 v[82:83], v50 offset:768
    s_add_u32 m0, s39, 40960
    v_mfma_f32_16x16x32_bf16 v[252:255], v[72:75], v[108:111], v[252:255]
    ds_read_b128 v[144:147], v49 offset:0
    buffer_load_dwordx4 v40, s[4:7], s37 offen offset:0 lds
    v_mfma_f32_16x16x32_bf16 v[252:255], v[76:79], v[124:127], v[252:255]
    ds_read_b64_tr_b16 v[84:85], v50 offset:6144
    v_mfma_f32_16x16x32_bf16 v[248:251], v[76:79], v[120:123], v[248:251]
    ds_read_b64_tr_b16 v[86:87], v50 offset:6912
    v_mfma_f32_16x16x32_bf16 v[248:251], v[72:75], v[104:107], v[248:251]
    ds_read_b128 v[148:151], v49 offset:2048
    v_mfma_f32_16x16x32_bf16 v[244:247], v[72:75], v[100:103], v[244:247]
    ds_read_b128 v[132:135], v48 offset:2048
    v_mfma_f32_16x16x32_bf16 v[244:247], v[76:79], v[116:119], v[244:247]
    ds_read_b128 v[136:139], v48 offset:4096
    buffer_load_dwordx4 v41, s[4:7], s37 offen offset:1024 lds
    v_mfma_f32_16x16x32_bf16 v[240:243], v[76:79], v[112:115], v[240:243]
    ds_read_b128 v[152:155], v49 offset:4096
    v_mfma_f32_16x16x32_bf16 v[240:243], v[72:75], v[96:99], v[240:243]
    ds_read_b128 v[156:159], v49 offset:6144
    s_waitcnt lgkmcnt(5)
    v_mfma_f32_16x16x32_bf16 v[160:163], v[80:83], v[128:131], v[160:163]
    ds_read_b128 v[140:143], v48 offset:6144
    v_mfma_f32_16x16x32_bf16 v[160:163], v[84:87], v[144:147], v[160:163]
    ds_read_b64_tr_b16 v[88:89], v50 offset:12288
    s_waitcnt lgkmcnt(5)
    v_mfma_f32_16x16x32_bf16 v[164:167], v[84:87], v[148:151], v[164:167]
    ds_read_b64_tr_b16 v[90:91], v50 offset:13056
    buffer_load_dwordx4 v42, s[4:7], s37 offen offset:2048 lds
    v_mfma_f32_16x16x32_bf16 v[164:167], v[80:83], v[132:135], v[164:167]
    ds_read_b64_tr_b16 v[92:93], v50 offset:18432
    s_waitcnt lgkmcnt(5)
    v_mfma_f32_16x16x32_bf16 v[168:171], v[80:83], v[136:139], v[168:171]
    ds_read_b64_tr_b16 v[94:95], v50 offset:19200
    v_mfma_f32_16x16x32_bf16 v[168:171], v[84:87], v[152:155], v[168:171]
    ds_read_b64_tr_b16 v[64:65], v51 offset:0
    s_waitcnt lgkmcnt(5)
    v_mfma_f32_16x16x32_bf16 v[172:175], v[84:87], v[156:159], v[172:175]
    ds_read_b64_tr_b16 v[66:67], v51 offset:768
    v_mfma_f32_16x16x32_bf16 v[172:175], v[80:83], v[140:143], v[172:175]
    ds_read_b64_tr_b16 v[68:69], v51 offset:6144
    buffer_load_dwordx4 v43, s[4:7], s37 offen offset:3072 lds
    s_waitcnt lgkmcnt(5)
    v_mfma_f32_16x16x32_bf16 v[188:191], v[88:91], v[140:143], v[188:191]
    ds_read_b64_tr_b16 v[70:71], v51 offset:6912
    s_waitcnt lgkmcnt(4)
    v_mfma_f32_16x16x32_bf16 v[188:191], v[92:95], v[156:159], v[188:191]
    ds_read_b64_tr_b16 v[72:73], v51 offset:12288
    v_mfma_f32_16x16x32_bf16 v[184:187], v[92:95], v[152:155], v[184:187]
    ds_read_b64_tr_b16 v[74:75], v51 offset:13056
    v_mfma_f32_16x16x32_bf16 v[184:187], v[88:91], v[136:139], v[184:187]
    ds_read_b64_tr_b16 v[76:77], v51 offset:18432
    s_add_u32 m0, s40, 57344
    v_mfma_f32_16x16x32_bf16 v[180:183], v[88:91], v[132:135], v[180:183]
    ds_read_b64_tr_b16 v[78:79], v51 offset:19200
    buffer_load_dwordx4 v44, s[8:11], s38 offen offset:0 lds
    v_mfma_f32_16x16x32_bf16 v[180:183], v[92:95], v[148:151], v[180:183]
    v_mfma_f32_16x16x32_bf16 v[176:179], v[92:95], v[144:147], v[176:179]
    ds_read_b64_tr_b16 v[80:81], v52 offset:0
    v_mfma_f32_16x16x32_bf16 v[176:179], v[88:91], v[128:131], v[176:179]
    ds_read_b64_tr_b16 v[82:83], v52 offset:768
    s_waitcnt lgkmcnt(6)
    v_mfma_f32_16x16x32_bf16 v[192:195], v[64:67], v[128:131], v[192:195]
    ds_read_b64_tr_b16 v[84:85], v52 offset:6144
    buffer_load_dwordx4 v45, s[8:11], s38 offen offset:1024 lds
    v_mfma_f32_16x16x32_bf16 v[192:195], v[68:71], v[144:147], v[192:195]
    ds_read_b64_tr_b16 v[86:87], v52 offset:6912
    v_mfma_f32_16x16x32_bf16 v[196:199], v[68:71], v[148:151], v[196:199]
    ds_read_b64_tr_b16 v[88:89], v52 offset:12288
    v_mfma_f32_16x16x32_bf16 v[196:199], v[64:67], v[132:135], v[196:199]
    ds_read_b64_tr_b16 v[90:91], v52 offset:13056
    v_mfma_f32_16x16x32_bf16 v[200:203], v[64:67], v[136:139], v[200:203]
    ds_read_b64_tr_b16 v[92:93], v52 offset:18432
    v_mfma_f32_16x16x32_bf16 v[200:203], v[68:71], v[152:155], v[200:203]
    ds_read_b64_tr_b16 v[94:95], v52 offset:19200
    buffer_load_dwordx4 v46, s[8:11], s38 offen offset:2048 lds
    v_mfma_f32_16x16x32_bf16 v[204:207], v[68:71], v[156:159], v[204:207]
    v_mfma_f32_16x16x32_bf16 v[204:207], v[64:67], v[140:143], v[204:207]
    s_waitcnt lgkmcnt(4)
    v_mfma_f32_16x16x32_bf16 v[220:223], v[72:75], v[140:143], v[220:223]
    s_add_u32 m0, s40, 63488
    v_mfma_f32_16x16x32_bf16 v[220:223], v[76:79], v[156:159], v[220:223]
    buffer_load_dwordx4 v44, s[8:11], s44 offen offset:0 lds
    v_mfma_f32_16x16x32_bf16 v[216:219], v[76:79], v[152:155], v[216:219]
    v_mfma_f32_16x16x32_bf16 v[216:219], v[72:75], v[136:139], v[216:219]
    v_mfma_f32_16x16x32_bf16 v[212:215], v[72:75], v[132:135], v[212:215]
    v_mfma_f32_16x16x32_bf16 v[212:215], v[76:79], v[148:151], v[212:215]
    buffer_load_dwordx4 v45, s[8:11], s44 offen offset:1024 lds
    v_mfma_f32_16x16x32_bf16 v[208:211], v[76:79], v[144:147], v[208:211]
    v_mfma_f32_16x16x32_bf16 v[208:211], v[72:75], v[128:131], v[208:211]
    v_mfma_f32_16x16x32_bf16 v[224:227], v[80:83], v[128:131], v[224:227]
    v_mfma_f32_16x16x32_bf16 v[224:227], v[84:87], v[144:147], v[224:227]
    buffer_load_dwordx4 v46, s[8:11], s44 offen offset:2048 lds
    v_mfma_f32_16x16x32_bf16 v[228:231], v[84:87], v[148:151], v[228:231]
    s_add_u32 s37, s37, 128
    s_cmpk_eq_u32 s37, 1280
    v_mfma_f32_16x16x32_bf16 v[228:231], v[80:83], v[132:135], v[228:231]
    s_cselect_b32 s37, 0, s37
    s_mul_i32 s38, s37, 1536
    v_mfma_f32_16x16x32_bf16 v[232:235], v[80:83], v[136:139], v[232:235]
    s_add_u32 s44, s38, 98304
    v_mfma_f32_16x16x32_bf16 v[232:235], v[84:87], v[152:155], v[232:235]
    s_waitcnt vmcnt(10) lgkmcnt(0)
    s_barrier
    ds_read_b128 v[96:99], v32 offset:0
    v_mfma_f32_16x16x32_bf16 v[236:239], v[84:87], v[156:159], v[236:239]
    ds_read_b64_tr_b16 v[64:65], v34 offset:0
    v_mfma_f32_16x16x32_bf16 v[236:239], v[80:83], v[140:143], v[236:239]
    ds_read_b64_tr_b16 v[66:67], v34 offset:768
    s_add_u32 m0, s39, 81920
    v_mfma_f32_16x16x32_bf16 v[252:255], v[88:91], v[140:143], v[252:255]
    ds_read_b128 v[112:115], v33 offset:0
    buffer_load_dwordx4 v40, s[4:7], s37 offen offset:0 lds
    v_mfma_f32_16x16x32_bf16 v[252:255], v[92:95], v[156:159], v[252:255]
    ds_read_b64_tr_b16 v[68:69], v34 offset:6144
    v_mfma_f32_16x16x32_bf16 v[248:251], v[92:95], v[152:155], v[248:251]
    ds_read_b64_tr_b16 v[70:71], v34 offset:6912
    v_mfma_f32_16x16x32_bf16 v[248:251], v[88:91], v[136:139], v[248:251]
    ds_read_b128 v[116:119], v33 offset:2048
    v_mfma_f32_16x16x32_bf16 v[244:247], v[88:91], v[132:135], v[244:247]
    ds_read_b128 v[100:103], v32 offset:2048
    v_mfma_f32_16x16x32_bf16 v[244:247], v[92:95], v[148:151], v[244:247]
    ds_read_b128 v[104:107], v32 offset:4096
    buffer_load_dwordx4 v41, s[4:7], s37 offen offset:1024 lds
    v_mfma_f32_16x16x32_bf16 v[240:243], v[92:95], v[144:147], v[240:243]
    ds_read_b128 v[120:123], v33 offset:4096
    v_mfma_f32_16x16x32_bf16 v[240:243], v[88:91], v[128:131], v[240:243]
    ds_read_b128 v[124:127], v33 offset:6144
    s_waitcnt lgkmcnt(5)
    v_mfma_f32_16x16x32_bf16 v[160:163], v[64:67], v[96:99], v[160:163]
    ds_read_b128 v[108:111], v32 offset:6144
    v_mfma_f32_16x16x32_bf16 v[160:163], v[68:71], v[112:115], v[160:163]
    ds_read_b64_tr_b16 v[72:73], v34 offset:12288
    s_waitcnt lgkmcnt(5)
    v_mfma_f32_16x16x32_bf16 v[164:167], v[68:71], v[116:119], v[164:167]
    ds_read_b64_tr_b16 v[74:75], v34 offset:13056
    buffer_load_dwordx4 v42, s[4:7], s37 offen offset:2048 lds
    v_mfma_f32_16x16x32_bf16 v[164:167], v[64:67], v[100:103], v[164:167]
    ds_read_b64_tr_b16 v[76:77], v34 offset:18432
    s_waitcnt lgkmcnt(5)
    v_mfma_f32_16x16x32_bf16 v[168:171], v[64:67], v[104:107], v[168:171]
    ds_read_b64_tr_b16 v[78:79], v34 offset:19200
    v_mfma_f32_16x16x32_bf16 v[168:171], v[68:71], v[120:123], v[168:171]
    ds_read_b64_tr_b16 v[80:81], v35 offset:0
    s_waitcnt lgkmcnt(5)
    v_mfma_f32_16x16x32_bf16 v[172:175], v[68:71], v[124:127], v[172:175]
    ds_read_b64_tr_b16 v[82:83], v35 offset:768
    v_mfma_f32_16x16x32_bf16 v[172:175], v[64:67], v[108:111], v[172:175]
    ds_read_b64_tr_b16 v[84:85], v35 offset:6144
    buffer_load_dwordx4 v43, s[4:7], s37 offen offset:3072 lds
    s_waitcnt lgkmcnt(5)
    v_mfma_f32_16x16x32_bf16 v[188:191], v[72:75], v[108:111], v[188:191]
    ds_read_b64_tr_b16 v[86:87], v35 offset:6912
    s_waitcnt lgkmcnt(4)
    v_mfma_f32_16x16x32_bf16 v[188:191], v[76:79], v[124:127], v[188:191]
    ds_read_b64_tr_b16 v[88:89], v35 offset:12288
    v_mfma_f32_16x16x32_bf16 v[184:187], v[76:79], v[120:123], v[184:187]
    ds_read_b64_tr_b16 v[90:91], v35 offset:13056
    v_mfma_f32_16x16x32_bf16 v[184:187], v[72:75], v[104:107], v[184:187]
    ds_read_b64_tr_b16 v[92:93], v35 offset:18432
    s_add_u32 m0, s40, 98304
    v_mfma_f32_16x16x32_bf16 v[180:183], v[72:75], v[100:103], v[180:183]
    ds_read_b64_tr_b16 v[94:95], v35 offset:19200
    buffer_load_dwordx4 v44, s[8:11], s38 offen offset:0 lds
    v_mfma_f32_16x16x32_bf16 v[180:183], v[76:79], v[116:119], v[180:183]
    v_mfma_f32_16x16x32_bf16 v[176:179], v[76:79], v[112:115], v[176:179]
    ds_read_b64_tr_b16 v[64:65], v36 offset:0
    v_mfma_f32_16x16x32_bf16 v[176:179], v[72:75], v[96:99], v[176:179]
    ds_read_b64_tr_b16 v[66:67], v36 offset:768
    s_waitcnt lgkmcnt(6)
    v_mfma_f32_16x16x32_bf16 v[192:195], v[80:83], v[96:99], v[192:195]
    ds_read_b64_tr_b16 v[68:69], v36 offset:6144
    buffer_load_dwordx4 v45, s[8:11], s38 offen offset:1024 lds
    v_mfma_f32_16x16x32_bf16 v[192:195], v[84:87], v[112:115], v[192:195]
    ds_read_b64_tr_b16 v[70:71], v36 offset:6912
    v_mfma_f32_16x16x32_bf16 v[196:199], v[84:87], v[116:119], v[196:199]
    ds_read_b64_tr_b16 v[72:73], v36 offset:12288
    v_mfma_f32_16x16x32_bf16 v[196:199], v[80:83], v[100:103], v[196:199]
    ds_read_b64_tr_b16 v[74:75], v36 offset:13056
    v_mfma_f32_16x16x32_bf16 v[200:203], v[80:83], v[104:107], v[200:203]
    ds_read_b64_tr_b16 v[76:77], v36 offset:18432
    v_mfma_f32_16x16x32_bf16 v[200:203], v[84:87], v[120:123], v[200:203]
    ds_read_b64_tr_b16 v[78:79], v36 offset:19200
    buffer_load_dwordx4 v46, s[8:11], s38 offen offset:2048 lds
    v_mfma_f32_16x16x32_bf16 v[204:207], v[84:87], v[124:127], v[204:207]
    v_mfma_f32_16x16x32_bf16 v[204:207], v[80:83], v[108:111], v[204:207]
    s_waitcnt lgkmcnt(4)
    v_mfma_f32_16x16x32_bf16 v[220:223], v[88:91], v[108:111], v[220:223]
    s_add_u32 m0, s40, 104448
    v_mfma_f32_16x16x32_bf16 v[220:223], v[92:95], v[124:127], v[220:223]
    buffer_load_dwordx4 v44, s[8:11], s44 offen offset:0 lds
    v_mfma_f32_16x16x32_bf16 v[216:219], v[92:95], v[120:123], v[216:219]
    v_mfma_f32_16x16x32_bf16 v[216:219], v[88:91], v[104:107], v[216:219]
    v_mfma_f32_16x16x32_bf16 v[212:215], v[88:91], v[100:103], v[212:215]
    v_mfma_f32_16x16x32_bf16 v[212:215], v[92:95], v[116:119], v[212:215]
    buffer_load_dwordx4 v45, s[8:11], s44 offen offset:1024 lds
    v_mfma_f32_16x16x32_bf16 v[208:211], v[92:95], v[112:115], v[208:211]
    v_mfma_f32_16x16x32_bf16 v[208:211], v[88:91], v[96:99], v[208:211]
    v_mfma_f32_16x16x32_bf16 v[224:227], v[64:67], v[96:99], v[224:227]
    v_mfma_f32_16x16x32_bf16 v[224:227], v[68:71], v[112:115], v[224:227]
    buffer_load_dwordx4 v46, s[8:11], s44 offen offset:2048 lds
    v_mfma_f32_16x16x32_bf16 v[228:231], v[68:71], v[116:119], v[228:231]
    s_add_u32 s37, s37, 128
    s_cmpk_eq_u32 s37, 1280
    v_mfma_f32_16x16x32_bf16 v[228:231], v[64:67], v[100:103], v[228:231]
    s_cselect_b32 s37, 0, s37
    s_mul_i32 s38, s37, 1536
    v_mfma_f32_16x16x32_bf16 v[232:235], v[64:67], v[104:107], v[232:235]
    s_add_u32 s44, s38, 98304
    v_mfma_f32_16x16x32_bf16 v[232:235], v[68:71], v[120:123], v[232:235]
    s_waitcnt vmcnt(10) lgkmcnt(0)
    s_barrier
    ds_read_b128 v[128:131], v32 offset:40960
    v_mfma_f32_16x16x32_bf16 v[236:239], v[68:71], v[124:127], v[236:239]
    ds_read_b64_tr_b16 v[80:81], v34 offset:40960
    buffer_load_dword v58, v59, s[24:27], 0 offen sc1
    v_mfma_f32_16x16x32_bf16 v[236:239], v[64:67], v[108:111], v[236:239]
    ds_read_b64_tr_b16 v[82:83], v34 offset:41728
    s_add_u32 m0, s39, 0
    v_mfma_f32_16x16x32_bf16 v[252:255], v[72:75], v[108:111], v[252:255]
    ds_read_b128 v[144:147], v33 offset:40960
    buffer_load_dwordx4 v40, s[4:7], s37 offen offset:0 lds
    v_mfma_f32_16x16x32_bf16 v[252:255], v[76:79], v[124:127], v[252:255]
    ds_read_b64_tr_b16 v[84:85], v34 offset:47104
    v_mfma_f32_16x16x32_bf16 v[248:251], v[76:79], v[120:123], v[248:251]
    ds_read_b64_tr_b16 v[86:87], v34 offset:47872
    v_mfma_f32_16x16x32_bf16 v[248:251], v[72:75], v[104:107], v[248:251]
    ds_read_b128 v[148:151], v33 offset:43008
    v_mfma_f32_16x16x32_bf16 v[244:247], v[72:75], v[100:103], v[244:247]
    ds_read_b128 v[132:135], v32 offset:43008
    v_mfma_f32_16x16x32_bf16 v[244:247], v[76:79], v[116:119], v[244:247]
    ds_read_b128 v[136:139], v32 offset:45056
    buffer_load_dwordx4 v41, s[4:7], s37 offen offset:1024 lds
    v_mfma_f32_16x16x32_bf16 v[240:243], v[76:79], v[112:115], v[240:243]
    ds_read_b128 v[152:155], v33 offset:45056
    v_mfma_f32_16x16x32_bf16 v[240:243], v[72:75], v[96:99], v[240:243]
    ds_read_b128 v[156:159], v33 offset:47104
    s_waitcnt lgkmcnt(5)
    v_mfma_f32_16x16x32_bf16 v[160:163], v[80:83], v[128:131], v[160:163]
    ds_read_b128 v[140:143], v32 offset:47104
    v_mfma_f32_16x16x32_bf16 v[160:163], v[84:87], v[144:147], v[160:163]
    ds_read_b64_tr_b16 v[88:89], v34 offset:53248
    s_waitcnt lgkmcnt(5)
    v_mfma_f32_16x16x32_bf16 v[164:167], v[84:87], v[148:151], v[164:167]
    ds_read_b64_tr_b16 v[90:91], v34 offset:54016
    buffer_load_dwordx4 v42, s[4:7], s37 offen offset:2048 lds
    v_mfma_f32_16x16x32_bf16 v[164:167], v[80:83], v[132:135], v[164:167]
    ds_read_b64_tr_b16 v[92:93], v34 offset:59392
    s_waitcnt lgkmcnt(5)
    v_mfma_f32_16x16x32_bf16 v[168:171], v[80:83], v[136:139], v[168:171]
    ds_read_b64_tr_b16 v[94:95], v34 offset:60160
    v_mfma_f32_16x16x32_bf16 v[168:171], v[84:87], v[152:155], v[168:171]
    ds_read_b64_tr_b16 v[64:65], v35 offset:40960
    s_waitcnt lgkmcnt(5)
    v_mfma_f32_16x16x32_bf16 v[172:175], v[84:87], v[156:159], v[172:175]
    ds_read_b64_tr_b16 v[66:67], v35 offset:41728
    v_mfma_f32_16x16x32_bf16 v[172:175], v[80:83], v[140:143], v[172:175]
    ds_read_b64_tr_b16 v[68:69], v35 offset:47104
    buffer_load_dwordx4 v43, s[4:7], s37 offen offset:3072 lds
    s_waitcnt lgkmcnt(5)
    v_mfma_f32_16x16x32_bf16 v[188:191], v[88:91], v[140:143], v[188:191]
    ds_read_b64_tr_b16 v[70:71], v35 offset:47872
    s_waitcnt lgkmcnt(4)
    v_mfma_f32_16x16x32_bf16 v[188:191], v[92:95], v[156:159], v[188:191]
    ds_read_b64_tr_b16 v[72:73], v35 offset:53248
    v_mfma_f32_16x16x32_bf16 v[184:187], v[92:95], v[152:155], v[184:187]
    ds_read_b64_tr_b16 v[74:75], v35 offset:54016
    v_mfma_f32_16x16x32_bf16 v[184:187], v[88:91], v[136:139], v[184:187]
    ds_read_b64_tr_b16 v[76:77], v35 offset:59392
    s_add_u32 m0, s40, 16384
    v_mfma_f32_16x16x32_bf16 v[180:183], v[88:91], v[132:135], v[180:183]
    ds_read_b64_tr_b16 v[78:79], v35 offset:60160
    buffer_load_dwordx4 v44, s[8:11], s38 offen offset:0 lds
    v_mfma_f32_16x16x32_bf16 v[180:183], v[92:95], v[148:151], v[180:183]
    v_mfma_f32_16x16x32_bf16 v[176:179], v[92:95], v[144:147], v[176:179]
    ds_read_b64_tr_b16 v[80:81], v36 offset:40960
    v_mfma_f32_16x16x32_bf16 v[176:179], v[88:91], v[128:131], v[176:179]
    ds_read_b64_tr_b16 v[82:83], v36 offset:41728
    s_waitcnt lgkmcnt(6)
    v_mfma_f32_16x16x32_bf16 v[192:195], v[64:67], v[128:131], v[192:195]
    ds_read_b64_tr_b16 v[84:85], v36 offset:47104
    buffer_load_dwordx4 v45, s[8:11], s38 offen offset:1024 lds
    v_mfma_f32_16x16x32_bf16 v[192:195], v[68:71], v[144:147], v[192:195]
    ds_read_b64_tr_b16 v[86:87], v36 offset:47872
    v_mfma_f32_16x16x32_bf16 v[196:199], v[68:71], v[148:151], v[196:199]
    ds_read_b64_tr_b16 v[88:89], v36 offset:53248
    v_mfma_f32_16x16x32_bf16 v[196:199], v[64:67], v[132:135], v[196:199]
    ds_read_b64_tr_b16 v[90:91], v36 offset:54016
    v_mfma_f32_16x16x32_bf16 v[200:203], v[64:67], v[136:139], v[200:203]
    ds_read_b64_tr_b16 v[92:93], v36 offset:59392
    v_mfma_f32_16x16x32_bf16 v[200:203], v[68:71], v[152:155], v[200:203]
    ds_read_b64_tr_b16 v[94:95], v36 offset:60160
    buffer_load_dwordx4 v46, s[8:11], s38 offen offset:2048 lds
    v_mfma_f32_16x16x32_bf16 v[204:207], v[68:71], v[156:159], v[204:207]
    v_mfma_f32_16x16x32_bf16 v[204:207], v[64:67], v[140:143], v[204:207]
    s_waitcnt lgkmcnt(4)
    v_mfma_f32_16x16x32_bf16 v[220:223], v[72:75], v[140:143], v[220:223]
    s_add_u32 m0, s40, 22528
    v_mfma_f32_16x16x32_bf16 v[220:223], v[76:79], v[156:159], v[220:223]
    buffer_load_dwordx4 v44, s[8:11], s44 offen offset:0 lds
    v_mfma_f32_16x16x32_bf16 v[216:219], v[76:79], v[152:155], v[216:219]
    v_mfma_f32_16x16x32_bf16 v[216:219], v[72:75], v[136:139], v[216:219]
    v_mfma_f32_16x16x32_bf16 v[212:215], v[72:75], v[132:135], v[212:215]
    v_mfma_f32_16x16x32_bf16 v[212:215], v[76:79], v[148:151], v[212:215]
    buffer_load_dwordx4 v45, s[8:11], s44 offen offset:1024 lds
    v_mfma_f32_16x16x32_bf16 v[208:211], v[76:79], v[144:147], v[208:211]
    v_mfma_f32_16x16x32_bf16 v[208:211], v[72:75], v[128:131], v[208:211]
    v_mfma_f32_16x16x32_bf16 v[224:227], v[80:83], v[128:131], v[224:227]
    v_mfma_f32_16x16x32_bf16 v[224:227], v[84:87], v[144:147], v[224:227]
    buffer_load_dwordx4 v46, s[8:11], s44 offen offset:2048 lds
    v_mfma_f32_16x16x32_bf16 v[228:231], v[84:87], v[148:151], v[228:231]
    v_mfma_f32_16x16x32_bf16 v[228:231], v[80:83], v[132:135], v[228:231]
    v_mfma_f32_16x16x32_bf16 v[232:235], v[80:83], v[136:139], v[232:235]
    v_mfma_f32_16x16x32_bf16 v[232:235], v[84:87], v[152:155], v[232:235]
    s_waitcnt vmcnt(11) lgkmcnt(0)
    s_barrier
    ds_read_b128 v[96:99], v48 offset:0
    v_mfma_f32_16x16x32_bf16 v[236:239], v[84:87], v[156:159], v[236:239]
    ds_read_b64_tr_b16 v[64:65], v50 offset:0
    v_mfma_f32_16x16x32_bf16 v[236:239], v[80:83], v[140:143], v[236:239]
    ds_read_b64_tr_b16 v[66:67], v50 offset:768
    v_mfma_f32_16x16x32_bf16 v[252:255], v[88:91], v[140:143], v[252:255]
    ds_read_b128 v[112:115], v49 offset:0
    v_mfma_f32_16x16x32_bf16 v[252:255], v[92:95], v[156:159], v[252:255]
    ds_read_b64_tr_b16 v[68:69], v50 offset:6144
    v_mfma_f32_16x16x32_bf16 v[248:251], v[92:95], v[152:155], v[248:251]
    ds_read_b64_tr_b16 v[70:71], v50 offset:6912
    v_mfma_f32_16x16x32_bf16 v[248:251], v[88:91], v[136:139], v[248:251]
    ds_read_b128 v[116:119], v49 offset:2048
    v_mfma_f32_16x16x32_bf16 v[244:247], v[88:91], v[132:135], v[244:247]
    ds_read_b128 v[100:103], v48 offset:2048
    v_mfma_f32_16x16x32_bf16 v[244:247], v[92:95], v[148:151], v[244:247]
    ds_read_b128 v[104:107], v48 offset:4096
    v_mfma_f32_16x16x32_bf16 v[240:243], v[92:95], v[144:147], v[240:243]
    ds_read_b128 v[120:123], v49 offset:4096
    s_waitcnt vmcnt(10)
    v_cmp_ne_u32 vcc, 12, v58
    s_cbranch_vccnz L_rchk
L_rchk_ok:
    v_mfma_f32_16x16x32_bf16 v[240:243], v[88:91], v[128:131], v[240:243]
    ds_read_b128 v[124:127], v49 offset:6144
    s_add_u32 s59, s78, 0
    s_waitcnt lgkmcnt(5)
    v_mfma_f32_16x16x32_bf16 v[160:163], v[64:67], v[96:99], v[160:163]
    ds_read_b128 v[108:111], v48 offset:6144
    buffer_load_dwordx4 a[0:3], v6, s[24:27], s59 offen offset:0 sc1
    v_mfma_f32_16x16x32_bf16 v[160:163], v[68:71], v[112:115], v[160:163]
    ds_read_b64_tr_b16 v[72:73], v50 offset:12288
    s_waitcnt lgkmcnt(5)
    v_mfma_f32_16x16x32_bf16 v[164:167], v[68:71], v[116:119], v[164:167]
    ds_read_b64_tr_b16 v[74:75], v50 offset:13056
    v_mfma_f32_16x16x32_bf16 v[164:167], v[64:67], v[100:103], v[164:167]
    ds_read_b64_tr_b16 v[76:77], v50 offset:18432
    buffer_load_dwordx4 a[4:7], v6, s[24:27], s59 offen offset:1024 sc1
    s_waitcnt lgkmcnt(5)
    v_mfma_f32_16x16x32_bf16 v[168:171], v[64:67], v[104:107], v[168:171]
    ds_read_b64_tr_b16 v[78:79], v50 offset:19200
    v_mfma_f32_16x16x32_bf16 v[168:171], v[68:71], v[120:123], v[168:171]
    ds_read_b64_tr_b16 v[80:81], v51 offset:0
    s_waitcnt lgkmcnt(5)
    v_mfma_f32_16x16x32_bf16 v[172:175], v[68:71], v[124:127], v[172:175]
    ds_read_b64_tr_b16 v[82:83], v51 offset:768
    v_mfma_f32_16x16x32_bf16 v[172:175], v[64:67], v[108:111], v[172:175]
    ds_read_b64_tr_b16 v[84:85], v51 offset:6144
    buffer_load_dwordx4 a[8:11], v6, s[24:27], s59 offen offset:2048 sc1
    s_waitcnt lgkmcnt(5)
    v_mfma_f32_16x16x32_bf16 v[188:191], v[72:75], v[108:111], v[188:191]
    ds_read_b64_tr_b16 v[86:87], v51 offset:6912
    s_waitcnt lgkmcnt(4)
    v_mfma_f32_16x16x32_bf16 v[188:191], v[76:79], v[124:127], v[188:191]
    ds_read_b64_tr_b16 v[88:89], v51 offset:12288
    v_mfma_f32_16x16x32_bf16 v[184:187], v[76:79], v[120:123], v[184:187]
    ds_read_b64_tr_b16 v[90:91], v51 offset:13056
    buffer_load_dwordx4 a[12:15], v6, s[24:27], s59 offen offset:3072 sc1
    v_mfma_f32_16x16x32_bf16 v[184:187], v[72:75], v[104:107], v[184:187]
    ds_read_b64_tr_b16 v[92:93], v51 offset:18432
    v_mfma_f32_16x16x32_bf16 v[180:183], v[72:75], v[100:103], v[180:183]
    ds_read_b64_tr_b16 v[94:95], v51 offset:19200
    v_mfma_f32_16x16x32_bf16 v[180:183], v[76:79], v[116:119], v[180:183]
    v_mfma_f32_16x16x32_bf16 v[176:179], v[76:79], v[112:115], v[176:179]
    ds_read_b64_tr_b16 v[64:65], v52 offset:0
    buffer_load_dwordx4 a[16:19], v7, s[24:27], s59 offen offset:0 sc1
    v_mfma_f32_16x16x32_bf16 v[176:179], v[72:75], v[96:99], v[176:179]
    ds_read_b64_tr_b16 v[66:67], v52 offset:768
    s_waitcnt lgkmcnt(6)
    v_mfma_f32_16x16x32_bf16 v[192:195], v[80:83], v[96:99], v[192:195]
    ds_read_b64_tr_b16 v[68:69], v52 offset:6144
    v_mfma_f32_16x16x32_bf16 v[192:195], v[84:87], v[112:115], v[192:195]
    ds_read_b64_tr_b16 v[70:71], v52 offset:6912
    s_add_u32 s59, s78, 5120
    v_mfma_f32_16x16x32_bf16 v[196:199], v[84:87], v[116:119], v[196:199]
    ds_read_b64_tr_b16 v[72:73], v52 offset:12288
    buffer_load_dwordx4 a[20:23], v6, s[24:27], s59 offen offset:0 sc1
    v_mfma_f32_16x16x32_bf16 v[196:199], v[80:83], v[100:103], v[196:199]
    ds_read_b64_tr_b16 v[74:75], v52 offset:13056
    v_mfma_f32_16x16x32_bf16 v[200:203], v[80:83], v[104:107], v[200:203]
    ds_read_b64_tr_b16 v[76:77], v52 offset:18432
    v_mfma_f32_16x16x32_bf16 v[200:203], v[84:87], v[120:123], v[200:203]
    ds_read_b64_tr_b16 v[78:79], v52 offset:19200
    buffer_load_dwordx4 a[24:27], v6, s[24:27], s59 offen offset:1024 sc1
    v_mfma_f32_16x16x32_bf16 v[204:207], v[84:87], v[124:127], v[204:207]
    v_mfma_f32_16x16x32_bf16 v[204:207], v[80:83], v[108:111], v[204:207]
    s_waitcnt lgkmcnt(4)
    v_mfma_f32_16x16x32_bf16 v[220:223], v[88:91], v[108:111], v[220:223]
    v_mfma_f32_16x16x32_bf16 v[220:223], v[92:95], v[124:127], v[220:223]
    buffer_load_dwordx4 a[28:31], v6, s[24:27], s59 offen offset:2048 sc1
    v_mfma_f32_16x16x32_bf16 v[216:219], v[92:95], v[120:123], v[216:219]
    v_mfma_f32_16x16x32_bf16 v[216:219], v[88:91], v[104:107], v[216:219]
    v_mfma_f32_16x16x32_bf16 v[212:215], v[88:91], v[100:103], v[212:215]
    buffer_load_dwordx4 a[32:35], v6, s[24:27], s59 offen offset:3072 sc1
    v_mfma_f32_16x16x32_bf16 v[212:215], v[92:95], v[116:119], v[212:215]
    v_mfma_f32_16x16x32_bf16 v[208:211], v[92:95], v[112:115], v[208:211]
    v_mfma_f32_16x16x32_bf16 v[208:211], v[88:91], v[96:99], v[208:211]
    v_mfma_f32_16x16x32_bf16 v[224:227], v[64:67], v[96:99], v[224:227]
    buffer_load_dwordx4 a[36:39], v7, s[24:27], s59 offen offset:0 sc1
    v_mfma_f32_16x16x32_bf16 v[224:227], v[68:71], v[112:115], v[224:227]
    v_mfma_f32_16x16x32_bf16 v[228:231], v[68:71], v[116:119], v[228:231]
    v_mfma_f32_16x16x32_bf16 v[228:231], v[64:67], v[100:103], v[228:231]
    v_mfma_f32_16x16x32_bf16 v[232:235], v[64:67], v[104:107], v[232:235]
    v_mfma_f32_16x16x32_bf16 v[232:235], v[68:71], v[120:123], v[232:235]
    s_waitcnt vmcnt(10) lgkmcnt(0)
    s_barrier
    ds_read_b128 v[128:131], v32 offset:0
    ds_read_b64_tr_b16 v[80:81], v34 offset:0
    v_mfma_f32_16x16x32_bf16 v[236:239], v[68:71], v[124:127], v[236:239]
    ds_read_b64_tr_b16 v[82:83], v34 offset:768
    ds_read_b128 v[144:147], v33 offset:0
    v_mfma_f32_16x16x32_bf16 v[236:239], v[64:67], v[108:111], v[236:239]
    ds_read_b64_tr_b16 v[84:85], v34 offset:6144
    ds_read_b64_tr_b16 v[86:87], v34 offset:6912
    s_add_u32 s59, s78, 10240
    buffer_load_dwordx4 a[40:43], v6, s[24:27], s59 offen offset:0 sc1
    v_mfma_f32_16x16x32_bf16 v[252:255], v[72:75], v[108:111], v[252:255]
    ds_read_b128 v[148:151], v33 offset:2048
    ds_read_b128 v[132:135], v32 offset:2048
    v_mfma_f32_16x16x32_bf16 v[252:255], v[76:79], v[124:127], v[252:255]
    ds_read_b64_tr_b16 v[88:89], v34 offset:12288
    ds_read_b64_tr_b16 v[90:91], v34 offset:13056
    buffer_load_dwordx4 a[44:47], v6, s[24:27], s59 offen offset:1024 sc1
    v_mfma_f32_16x16x32_bf16 v[248:251], v[76:79], v[120:123], v[248:251]
    ds_read_b64_tr_b16 v[92:93], v34 offset:18432
    ds_read_b64_tr_b16 v[94:95], v34 offset:19200
    v_mfma_f32_16x16x32_bf16 v[248:251], v[72:75], v[104:107], v[248:251]
    ds_read_b128 v[136:139], v32 offset:4096
    buffer_load_dwordx4 a[48:51], v6, s[24:27], s59 offen offset:2048 sc1
    v_mfma_f32_16x16x32_bf16 v[244:247], v[72:75], v[100:103], v[244:247]
    ds_read_b128 v[152:155], v33 offset:4096
    v_mfma_f32_16x16x32_bf16 v[244:247], v[76:79], v[116:119], v[244:247]
    ds_read_b128 v[156:159], v33 offset:6144
    buffer_load_dwordx4 a[52:55], v6, s[24:27], s59 offen offset:3072 sc1
    v_mfma_f32_16x16x32_bf16 v[240:243], v[76:79], v[112:115], v[240:243]
    ds_read_b128 v[140:143], v32 offset:6144
    v_mfma_f32_16x16x32_bf16 v[240:243], v[72:75], v[96:99], v[240:243]
    buffer_load_dwordx4 a[56:59], v7, s[24:27], s59 offen offset:0 sc1
    s_waitcnt lgkmcnt(8)
    v_mfma_f32_16x16x32_bf16 v[160:163], v[80:83], v[128:131], v[160:163]
    ds_read_b64_tr_b16 v[64:65], v35 offset:0
    v_mfma_f32_16x16x32_bf16 v[160:163], v[84:87], v[144:147], v[160:163]
    ds_read_b64_tr_b16 v[66:67], v35 offset:768
    s_add_u32 s59, s78, 15360
    buffer_load_dwordx4 a[60:63], v6, s[24:27], s59 offen offset:0 sc1
    v_mfma_f32_16x16x32_bf16 v[164:167], v[84:87], v[148:151], v[164:167]
    ds_read_b64_tr_b16 v[68:69], v35 offset:6144
    v_mfma_f32_16x16x32_bf16 v[164:167], v[80:83], v[132:135], v[164:167]
    ds_read_b64_tr_b16 v[70:71], v35 offset:6912
    s_waitcnt lgkmcnt(8)
    v_mfma_f32_16x16x32_bf16 v[180:183], v[88:91], v[132:135], v[180:183]
    ds_read_b64_tr_b16 v[72:73], v35 offset:12288
    v_mfma_f32_16x16x32_bf16 v[180:183], v[92:95], v[148:151], v[180:183]
    ds_read_b64_tr_b16 v[74:75], v35 offset:13056
    v_mfma_f32_16x16x32_bf16 v[176:179], v[92:95], v[144:147], v[176:179]
    ds_read_b64_tr_b16 v[76:77], v35 offset:18432
    v_mfma_f32_16x16x32_bf16 v[176:179], v[88:91], v[128:131], v[176:179]
    ds_read_b64_tr_b16 v[78:79], v35 offset:19200
    s_waitcnt lgkmcnt(8)
    v_mfma_f32_16x16x32_bf16 v[168:171], v[80:83], v[136:139], v[168:171]
    v_mfma_f32_16x16x32_bf16 v[168:171], v[84:87], v[152:155], v[168:171]
    v_mfma_f32_16x16x32_bf16 v[172:175], v[84:87], v[156:159], v[172:175]
    v_max_f32 v160, 0, v160
    v_max_f32 v161, 0, v161
    v_max_f32 v162, 0, v162
    v_mfma_f32_16x16x32_bf16 v[172:175], v[80:83], v[140:143], v[172:175]
    v_max_f32 v163, 0, v163
    v_max_f32 v164, 0, v164
    v_max_f32 v165, 0, v165
    v_mfma_f32_16x16x32_bf16 v[188:191], v[88:91], v[140:143], v[188:191]
    v_max_f32 v166, 0, v166
    v_max_f32 v167, 0, v167
    v_mul_f32 v160, v160, v176
    v_mfma_f32_16x16x32_bf16 v[188:191], v[92:95], v[156:159], v[188:191]
    v_mul_f32 v161, v161, v177
    v_mul_f32 v162, v162, v178
    v_mul_f32 v163, v163, v179
    v_mfma_f32_16x16x32_bf16 v[184:187], v[92:95], v[152:155], v[184:187]
    v_mul_f32 v164, v164, v180
    v_mul_f32 v165, v165, v181
    v_mul_f32 v166, v166, v182
    v_mfma_f32_16x16x32_bf16 v[184:187], v[88:91], v[136:139], v[184:187]
    v_mul_f32 v167, v167, v183
    v_cvt_pk_bf16_f32 v176, v160, v161
    v_cvt_pk_bf16_f32 v178, v164, v165
    s_waitcnt lgkmcnt(0)
    v_mfma_f32_16x16x32_bf16 v[192:195], v[64:67], v[128:131], v[192:195]
    ds_read_b64_tr_b16 v[80:81], v36 offset:0
    ds_read_b64_tr_b16 v[82:83], v36 offset:768
    v_cvt_pk_bf16_f32 v177, v162, v163
    v_cvt_pk_bf16_f32 v179, v166, v167
    v_mfma_f32_16x16x32_bf16 v[192:195], v[68:71], v[144:147], v[192:195]
    ds_read_b64_tr_b16 v[84:85], v36 offset:6144
    ds_read_b64_tr_b16 v[86:87], v36 offset:6912
    v_permlane16_swap_b32 v176, v178
    v_permlane16_swap_b32 v177, v179
    buffer_store_dwordx4 v[176:179], v57, s[24:27], s50 offen offset:0 sc1
    v_mfma_f32_16x16x32_bf16 v[196:199], v[68:71], v[148:151], v[196:199]
    ds_read_b64_tr_b16 v[88:89], v36 offset:12288
    ds_read_b64_tr_b16 v[90:91], v36 offset:13056
    v_max_f32 v168, 0, v168
    v_max_f32 v169, 0, v169
    v_max_f32 v170, 0, v170
    v_mfma_f32_16x16x32_bf16 v[196:199], v[64:67], v[132:135], v[196:199]
    ds_read_b64_tr_b16 v[92:93], v36 offset:18432
    ds_read_b64_tr_b16 v[94:95], v36 offset:19200
    v_max_f32 v171, 0, v171
    v_max_f32 v172, 0, v172
    v_max_f32 v173, 0, v173
    v_mfma_f32_16x16x32_bf16 v[212:215], v[72:75], v[132:135], v[212:215]
    v_max_f32 v174, 0, v174
    v_max_f32 v175, 0, v175
    v_mul_f32 v168, v168, v184
    v_mfma_f32_16x16x32_bf16 v[212:215], v[76:79], v[148:151], v[212:215]
    v_mul_f32 v169, v169, v185
    v_mul_f32 v170, v170, v186
    v_mul_f32 v171, v171, v187
    v_mfma_f32_16x16x32_bf16 v[208:211], v[76:79], v[144:147], v[208:211]
    v_mul_f32 v172, v172, v188
    v_mul_f32 v173, v173, v189
    v_mul_f32 v174, v174, v190
    v_mfma_f32_16x16x32_bf16 v[208:211], v[72:75], v[128:131], v[208:211]
    v_mul_f32 v175, v175, v191
    v_cvt_pk_bf16_f32 v184, v168, v169
    v_cvt_pk_bf16_f32 v186, v172, v173
    v_mfma_f32_16x16x32_bf16 v[200:203], v[64:67], v[136:139], v[200:203]
    v_cvt_pk_bf16_f32 v185, v170, v171
    v_cvt_pk_bf16_f32 v187, v174, v175
    v_mfma_f32_16x16x32_bf16 v[200:203], v[68:71], v[152:155], v[200:203]
    v_permlane16_swap_b32 v184, v186
    v_permlane16_swap_b32 v185, v187
    buffer_store_dwordx4 v[184:187], v57, s[24:27], s50 offen offset:2048 sc1
    v_mfma_f32_16x16x32_bf16 v[204:207], v[68:71], v[156:159], v[204:207]
    v_max_f32 v192, 0, v192
    v_max_f32 v193, 0, v193
    v_max_f32 v194, 0, v194
    v_mfma_f32_16x16x32_bf16 v[204:207], v[64:67], v[140:143], v[204:207]
    v_max_f32 v195, 0, v195
    v_max_f32 v196, 0, v196
    v_max_f32 v197, 0, v197
    v_mfma_f32_16x16x32_bf16 v[220:223], v[72:75], v[140:143], v[220:223]
    v_max_f32 v198, 0, v198
    v_max_f32 v199, 0, v199
    v_mul_f32 v192, v192, v208
    v_mfma_f32_16x16x32_bf16 v[220:223], v[76:79], v[156:159], v[220:223]
    v_mul_f32 v193, v193, v209
    v_mul_f32 v194, v194, v210
    v_mul_f32 v195, v195, v211
    v_mfma_f32_16x16x32_bf16 v[216:219], v[76:79], v[152:155], v[216:219]
    v_mul_f32 v196, v196, v212
    v_mul_f32 v197, v197, v213
    v_mul_f32 v198, v198, v214
    v_mfma_f32_16x16x32_bf16 v[216:219], v[72:75], v[136:139], v[216:219]
    v_mul_f32 v199, v199, v215
    v_cvt_pk_bf16_f32 v208, v192, v193
    v_cvt_pk_bf16_f32 v210, v196, v197
    s_waitcnt lgkmcnt(0)
    v_mfma_f32_16x16x32_bf16 v[224:227], v[80:83], v[128:131], v[224:227]
    v_cvt_pk_bf16_f32 v209, v194, v195
    v_cvt_pk_bf16_f32 v211, v198, v199
    v_mfma_f32_16x16x32_bf16 v[224:227], v[84:87], v[144:147], v[224:227]
    v_permlane16_swap_b32 v208, v210
    v_permlane16_swap_b32 v209, v211
    buffer_store_dwordx4 v[208:211], v57, s[24:27], s51 offen offset:0 sc1
    v_mfma_f32_16x16x32_bf16 v[228:231], v[84:87], v[148:151], v[228:231]
    v_max_f32 v200, 0, v200
    v_max_f32 v201, 0, v201
    v_max_f32 v202, 0, v202
    v_mfma_f32_16x16x32_bf16 v[228:231], v[80:83], v[132:135], v[228:231]
    v_max_f32 v203, 0, v203
    v_max_f32 v204, 0, v204
    v_max_f32 v205, 0, v205
    v_mfma_f32_16x16x32_bf16 v[244:247], v[88:91], v[132:135], v[244:247]
    v_max_f32 v206, 0, v206
    v_max_f32 v207, 0, v207
    v_mul_f32 v200, v200, v216
    v_mfma_f32_16x16x32_bf16 v[244:247], v[92:95], v[148:151], v[244:247]
    v_mul_f32 v201, v201, v217
    v_mul_f32 v202, v202, v218
    v_mul_f32 v203, v203, v219
    v_mfma_f32_16x16x32_bf16 v[240:243], v[92:95], v[144:147], v[240:243]
    v_mul_f32 v204, v204, v220
    v_mul_f32 v205, v205, v221
    v_mul_f32 v206, v206, v222
    v_mfma_f32_16x16x32_bf16 v[240:243], v[88:91], v[128:131], v[240:243]
    v_mul_f32 v207, v207, v223
    v_cvt_pk_bf16_f32 v216, v200, v201
    v_cvt_pk_bf16_f32 v218, v204, v205
    v_mfma_f32_16x16x32_bf16 v[232:235], v[80:83], v[136:139], v[232:235]
    v_cvt_pk_bf16_f32 v217, v202, v203
    v_cvt_pk_bf16_f32 v219, v206, v207
    v_mfma_f32_16x16x32_bf16 v[232:235], v[84:87], v[152:155], v[232:235]
    v_permlane16_swap_b32 v216, v218
    v_permlane16_swap_b32 v217, v219
    buffer_store_dwordx4 v[216:219], v57, s[24:27], s51 offen offset:2048 sc1
    v_mfma_f32_16x16x32_bf16 v[236:239], v[84:87], v[156:159], v[236:239]
    v_max_f32 v224, 0, v224
    v_max_f32 v225, 0, v225
    v_max_f32 v226, 0, v226
    v_mfma_f32_16x16x32_bf16 v[236:239], v[80:83], v[140:143], v[236:239]
    v_max_f32 v227, 0, v227
    v_max_f32 v228, 0, v228
    v_max_f32 v229, 0, v229
    v_mfma_f32_16x16x32_bf16 v[252:255], v[88:91], v[140:143], v[252:255]
    v_max_f32 v230, 0, v230
    v_max_f32 v231, 0, v231
    v_mul_f32 v224, v224, v240
    v_mfma_f32_16x16x32_bf16 v[252:255], v[92:95], v[156:159], v[252:255]
    v_mul_f32 v225, v225, v241
    v_mul_f32 v226, v226, v242
    v_mul_f32 v227, v227, v243
    v_mfma_f32_16x16x32_bf16 v[248:251], v[92:95], v[152:155], v[248:251]
    v_mul_f32 v228, v228, v244
    v_mul_f32 v229, v229, v245
    v_mul_f32 v230, v230, v246
    v_mfma_f32_16x16x32_bf16 v[248:251], v[88:91], v[136:139], v[248:251]
    v_mul_f32 v231, v231, v247
    v_cvt_pk_bf16_f32 v240, v224, v225
    v_cvt_pk_bf16_f32 v242, v228, v229
    v_cvt_pk_bf16_f32 v241, v226, v227
    v_cvt_pk_bf16_f32 v243, v230, v231
    s_nop 0
    v_permlane16_swap_b32 v240, v242
    v_permlane16_swap_b32 v241, v243
    buffer_store_dwordx4 v[240:243], v57, s[24:27], s52 offen offset:0 sc1
    s_nop 3
    v_max_f32 v232, 0, v232
    v_max_f32 v233, 0, v233
    v_max_f32 v234, 0, v234
    v_max_f32 v235, 0, v235
    v_max_f32 v236, 0, v236
    v_max_f32 v237, 0, v237
    v_max_f32 v238, 0, v238
    v_max_f32 v239, 0, v239
    v_pk_mul_f32 v[232:233], v[232:233], v[248:249]
    v_pk_mul_f32 v[234:235], v[234:235], v[250:251]
    v_pk_mul_f32 v[236:237], v[236:237], v[252:253]
    v_pk_mul_f32 v[238:239], v[238:239], v[254:255]
    v_cvt_pk_bf16_f32 v248, v232, v233
    v_cvt_pk_bf16_f32 v249, v234, v235
    v_cvt_pk_bf16_f32 v250, v236, v237
    v_cvt_pk_bf16_f32 v251, v238, v239
    s_nop 1
    v_permlane16_swap_b32 v248, v250
    v_permlane16_swap_b32 v249, v251
    buffer_store_dwordx4 v[248:251], v57, s[24:27], s52 offen offset:2048 sc1
    buffer_load_dwordx4 a[64:67], v6, s[24:27], s59 offen offset:1024 sc1
    buffer_load_dwordx4 a[68:71], v6, s[24:27], s59 offen offset:2048 sc1
    buffer_load_dwordx4 a[72:75], v6, s[24:27], s59 offen offset:3072 sc1
    buffer_load_dwordx4 a[76:79], v7, s[24:27], s59 offen offset:0 sc1
    s_add_u32 s59, s78, 20480
    buffer_load_dwordx4 a[80:83], v6, s[24:27], s59 offen offset:0 sc1
    buffer_load_dwordx4 a[84:87], v6, s[24:27], s59 offen offset:1024 sc1
    buffer_load_dwordx4 a[88:91], v6, s[24:27], s59 offen offset:2048 sc1
    buffer_load_dwordx4 a[92:95], v6, s[24:27], s59 offen offset:3072 sc1
    buffer_load_dwordx4 a[96:99], v7, s[24:27], s59 offen offset:0 sc1
    s_add_u32 s59, s78, 25600
    buffer_load_dwordx4 a[100:103], v6, s[24:27], s59 offen offset:0 sc1
    buffer_load_dwordx4 a[104:107], v6, s[24:27], s59 offen offset:1024 sc1
    buffer_load_dwordx4 a[108:111], v6, s[24:27], s59 offen offset:2048 sc1
    s_waitcnt vmcnt(12)
    s_barrier
    s_mov_b64 exec, 1
    buffer_atomic_add v13, v26, s[24:27], 0 offen sc1
    s_mov_b64 exec, -1
    v_mov_b32 v2, 0
    buffer_load_dwordx4 a[112:115], v6, s[24:27], s59 offen offset:3072 sc1
    buffer_load_dwordx4 a[116:119], v7, s[24:27], s59 offen offset:0 sc1
    s_add_u32 s59, s78, 30720
    buffer_load_dwordx4 a[120:123], v6, s[24:27], s59 offen offset:0 sc1
    buffer_load_dwordx4 a[124:127], v6, s[24:27], s59 offen offset:1024 sc1
    buffer_load_dwordx4 a[128:131], v6, s[24:27], s59 offen offset:2048 sc1
    buffer_load_dwordx4 a[132:135], v6, s[24:27], s59 offen offset:3072 sc1
    buffer_load_dwordx4 a[136:139], v7, s[24:27], s59 offen offset:0 sc1
    s_add_u32 s59, s78, 35840
    buffer_load_dwordx4 a[140:143], v6, s[24:27], s59 offen offset:0 sc1
    buffer_load_dwordx4 a[144:147], v6, s[24:27], s59 offen offset:1024 sc1
    buffer_load_dwordx4 a[148:151], v6, s[24:27], s59 offen offset:2048 sc1
    buffer_load_dwordx4 a[152:155], v6, s[24:27], s59 offen offset:3072 sc1
    buffer_load_dwordx4 a[156:159], v7, s[24:27], s59 offen offset:0 sc1
    s_add_u32 s59, s78, 40960
    buffer_load_dwordx4 a[160:163], v6, s[24:27], s59 offen offset:0 sc1
    buffer_load_dwordx4 a[164:167], v6, s[24:27], s59 offen offset:1024 sc1
    buffer_load_dwordx4 a[168:171], v6, s[24:27], s59 offen offset:2048 sc1
    buffer_load_dwordx4 a[172:175], v6, s[24:27], s59 offen offset:3072 sc1
    buffer_load_dwordx4 a[176:179], v7, s[24:27], s59 offen offset:0 sc1
    s_add_u32 s59, s78, 46080
    buffer_load_dwordx4 a[180:183], v6, s[24:27], s59 offen offset:0 sc1
    buffer_load_dwordx4 a[184:187], v6, s[24:27], s59 offen offset:1024 sc1
    buffer_load_dwordx4 a[188:191], v6, s[24:27], s59 offen offset:2048 sc1
    buffer_load_dwordx4 a[192:195], v6, s[24:27], s59 offen offset:3072 sc1
    buffer_load_dwordx4 a[196:199], v7, s[24:27], s59 offen offset:0 sc1
    buffer_load_dword v3, v2, s[24:27], s58 offen sc1
    s_add_u32 s59, s78, 51200
    buffer_load_dwordx4 a[200:203], v6, s[24:27], s59 offen offset:0 sc1
    buffer_load_dwordx4 a[204:207], v6, s[24:27], s59 offen offset:1024 sc1
    buffer_load_dwordx4 a[208:211], v6, s[24:27], s59 offen offset:2048 sc1
    buffer_load_dwordx4 a[212:215], v6, s[24:27], s59 offen offset:3072 sc1
    buffer_load_dwordx4 a[216:219], v7, s[24:27], s59 offen offset:0 sc1
    s_add_u32 s59, s78, 56320
    buffer_load_dwordx4 a[220:223], v6, s[24:27], s59 offen offset:0 sc1
    buffer_load_dwordx4 a[224:227], v6, s[24:27], s59 offen offset:1024 sc1
    buffer_load_dwordx4 a[228:231], v6, s[24:27], s59 offen offset:2048 sc1
    buffer_load_dwordx4 a[232:235], v6, s[24:27], s59 offen offset:3072 sc1
    buffer_load_dwordx4 a[236:239], v7, s[24:27], s59 offen offset:0 sc1
    s_waitcnt vmcnt(10)
    v_cmp_ne_u32 vcc, 4, v3
    s_cbranch_vccnz L_poll
L_poll_ok:
    buffer_load_dwordx4 v[64:67], v60, s[24:27], s64 offen sc1
    buffer_load_dwordx4 v[68:71], v60, s[24:27], s65 offen sc1
    buffer_load_dwordx4 v[72:75], v60, s[24:27], s66 offen sc1
    buffer_load_dwordx4 v[76:79], v60, s[24:27], s67 offen sc1
    buffer_load_dwordx4 v[80:83], v60, s[24:27], s68 offen sc1
    buffer_load_dwordx4 v[84:87], v60, s[24:27], s69 offen sc1
    buffer_load_dwordx4 v[88:91], v60, s[24:27], s70 offen sc1
    buffer_load_dwordx4 v[92:95], v60, s[24:27], s71 offen sc1
    buffer_load_dwordx4 v[96:99], v60, s[24:27], s72 offen sc1
    buffer_load_dwordx4 v[100:103], v60, s[24:27], s73 offen sc1
    s_lshl_b32 s47, s32, 14
    v_lshl_add_u32 v2, v0, 3, s47
    s_add_u32 s47, s47, 16384
    s_and_b32 s47, s47, 0xffff
    v_lshl_add_u32 v3, v0, 3, s47
    v_and_b32 v15, 15, v0
    v_mul_u32_u24 v15, 1280, v15
    v_bfe_u32 v14, v0, 4, 1
    v_lshl_add_u32 v14, v14, 5, v15
    v_lshrrev_b32 v16, 5, v0
    v_lshl_add_u32 v14, v16, 4, v14
    v_lshrrev_b32 v16, 4, v0
    v_lshl_add_u32 v15, v16, 3, v15
    s_waitcnt vmcnt(8)
    v_mfma_f32_16x16x32_bf16 v[160:163], a[0:3], v[64:67], 0
    buffer_load_dwordx4 v[104:107], v60, s[24:27], s74 offen sc1
    v_mfma_f32_16x16x32_bf16 v[160:163], a[20:23], v[68:71], v[160:163]
    v_mfma_f32_16x16x32_bf16 v[164:167], a[24:27], v[68:71], 0
    v_mfma_f32_16x16x32_bf16 v[164:167], a[4:7], v[64:67], v[164:167]
    v_mfma_f32_16x16x32_bf16 v[168:171], a[8:11], v[64:67], 0
    v_mfma_f32_16x16x32_bf16 v[168:171], a[28:31], v[68:71], v[168:171]
    buffer_load_dwordx4 v[108:111], v60, s[24:27], s75 offen sc1
    v_mfma_f32_16x16x32_bf16 v[172:175], a[32:35], v[68:71], 0
    v_mfma_f32_16x16x32_bf16 v[172:175], a[12:15], v[64:67], v[172:175]
    v_mfma_f32_16x16x32_bf16 v[176:179], a[16:19], v[64:67], 0
    v_mfma_f32_16x16x32_bf16 v[176:179], a[36:39], v[68:71], v[176:179]
    s_waitcnt vmcnt(8)
    v_mfma_f32_16x16x32_bf16 v[160:163], a[40:43], v[72:75], v[160:163]
    buffer_load_dwordx4 v[112:115], v61, s[24:27], s64 offen sc1
    v_mfma_f32_16x16x32_bf16 v[160:163], a[60:63], v[76:79], v[160:163]
    v_mfma_f32_16x16x32_bf16 v[164:167], a[64:67], v[76:79], v[164:167]
    v_mfma_f32_16x16x32_bf16 v[164:167], a[44:47], v[72:75], v[164:167]
    v_mfma_f32_16x16x32_bf16 v[168:171], a[48:51], v[72:75], v[168:171]
    v_mfma_f32_16x16x32_bf16 v[168:171], a[68:71], v[76:79], v[168:171]
    buffer_load_dwordx4 v[116:119], v61, s[24:27], s65 offen sc1
    v_mfma_f32_16x16x32_bf16 v[172:175], a[72:75], v[76:79], v[172:175]
    v_mfma_f32_16x16x32_bf16 v[172:175], a[52:55], v[72:75], v[172:175]
    v_mfma_f32_16x16x32_bf16 v[176:179], a[56:59], v[72:75], v[176:179]
    v_mfma_f32_16x16x32_bf16 v[176:179], a[76:79], v[76:79], v[176:179]
    s_waitcnt vmcnt(8)
    v_mfma_f32_16x16x32_bf16 v[160:163], a[80:83], v[80:83], v[160:163]
    buffer_load_dwordx4 v[120:123], v61, s[24:27], s66 offen sc1
    v_mfma_f32_16x16x32_bf16 v[160:163], a[100:103], v[84:87], v[160:163]
    v_mfma_f32_16x16x32_bf16 v[164:167], a[104:107], v[84:87], v[164:167]
    v_mfma_f32_16x16x32_bf16 v[164:167], a[84:87], v[80:83], v[164:167]
    v_mfma_f32_16x16x32_bf16 v[168:171], a[88:91], v[80:83], v[168:171]
    v_mfma_f32_16x16x32_bf16 v[168:171], a[108:111], v[84:87], v[168:171]
    buffer_load_dwordx4 v[124:127], v61, s[24:27], s67 offen sc1
    v_mfma_f32_16x16x32_bf16 v[172:175], a[112:115], v[84:87], v[172:175]
    v_mfma_f32_16x16x32_bf16 v[172:175], a[92:95], v[80:83], v[172:175]
    v_mfma_f32_16x16x32_bf16 v[176:179], a[96:99], v[80:83], v[176:179]
    v_mfma_f32_16x16x32_bf16 v[176:179], a[116:119], v[84:87], v[176:179]
    s_waitcnt vmcnt(8)
    v_mfma_f32_16x16x32_bf16 v[160:163], a[120:123], v[88:91], v[160:163]
    buffer_load_dwordx4 v[64:67], v61, s[24:27], s68 offen sc1
    v_mfma_f32_16x16x32_bf16 v[160:163], a[140:143], v[92:95], v[160:163]
    v_mfma_f32_16x16x32_bf16 v[164:167], a[144:147], v[92:95], v[164:167]
    v_mfma_f32_16x16x32_bf16 v[164:167], a[124:127], v[88:91], v[164:167]
    v_mfma_f32_16x16x32_bf16 v[168:171], a[128:131], v[88:91], v[168:171]
    v_mfma_f32_16x16x32_bf16 v[168:171], a[148:151], v[92:95], v[168:171]
    buffer_load_dwordx4 v[68:71], v61, s[24:27], s69 offen sc1
    v_mfma_f32_16x16x32_bf16 v[172:175], a[152:155], v[92:95], v[172:175]
    v_mfma_f32_16x16x32_bf16 v[172:175], a[132:135], v[88:91], v[172:175]
    v_mfma_f32_16x16x32_bf16 v[176:179], a[136:139], v[88:91], v[176:179]
    v_mfma_f32_16x16x32_bf16 v[176:179], a[156:159], v[92:95], v[176:179]
    s_waitcnt vmcnt(8)
    v_mfma_f32_16x16x32_bf16 v[160:163], a[160:163], v[96:99], v[160:163]
    buffer_load_dwordx4 v[72:75], v61, s[24:27], s70 offen sc1
    v_mfma_f32_16x16x32_bf16 v[160:163], a[180:183], v[100:103], v[160:163]
    v_mfma_f32_16x16x32_bf16 v[164:167], a[184:187], v[100:103], v[164:167]
    v_mfma_f32_16x16x32_bf16 v[164:167], a[164:167], v[96:99], v[164:167]
    v_mfma_f32_16x16x32_bf16 v[168:171], a[168:171], v[96:99], v[168:171]
    v_mfma_f32_16x16x32_bf16 v[168:171], a[188:191], v[100:103], v[168:171]
    buffer_load_dwordx4 v[76:79], v61, s[24:27], s71 offen sc1
    v_mfma_f32_16x16x32_bf16 v[172:175], a[192:195], v[100:103], v[172:175]
    v_mfma_f32_16x16x32_bf16 v[172:175], a[172:175], v[96:99], v[172:175]
    v_mfma_f32_16x16x32_bf16 v[176:179], a[176:179], v[96:99], v[176:179]
    v_mfma_f32_16x16x32_bf16 v[176:179], a[196:199], v[100:103], v[176:179]
    s_waitcnt vmcnt(8)
    v_mfma_f32_16x16x32_bf16 v[160:163], a[200:203], v[104:107], v[160:163]
    buffer_load_dwordx4 v[80:83], v61, s[24:27], s72 offen sc1
    v_mfma_f32_16x16x32_bf16 v[160:163], a[220:223], v[108:111], v[160:163]
    v_mfma_f32_16x16x32_bf16 v[164:167], a[224:227], v[108:111], v[164:167]
    v_mfma_f32_16x16x32_bf16 v[164:167], a[204:207], v[104:107], v[164:167]
    v_mfma_f32_16x16x32_bf16 v[168:171], a[208:211], v[104:107], v[168:171]
    v_mfma_f32_16x16x32_bf16 v[168:171], a[228:231], v[108:111], v[168:171]
    buffer_load_dwordx4 v[84:87], v61, s[24:27], s73 offen sc1
    v_mfma_f32_16x16x32_bf16 v[172:175], a[232:235], v[108:111], v[172:175]
    v_mfma_f32_16x16x32_bf16 v[172:175], a[212:215], v[104:107], v[172:175]
    v_mfma_f32_16x16x32_bf16 v[176:179], a[216:219], v[104:107], v[176:179]
    v_mfma_f32_16x16x32_bf16 v[176:179], a[236:239], v[108:111], v[176:179]
    s_waitcnt vmcnt(6)
    v_mfma_f32_16x16x32_bf16 v[180:183], a[0:3], v[112:115], 0
    buffer_load_dwordx4 v[88:91], v61, s[24:27], s74 offen sc1
    v_mfma_f32_16x16x32_bf16 v[180:183], a[20:23], v[116:119], v[180:183]
    v_mfma_f32_16x16x32_bf16 v[180:183], a[40:43], v[120:123], v[180:183]
    v_mfma_f32_16x16x32_bf16 v[180:183], a[60:63], v[124:127], v[180:183]
    v_mfma_f32_16x16x32_bf16 v[184:187], a[64:67], v[124:127], 0
    v_mfma_f32_16x16x32_bf16 v[184:187], a[44:47], v[120:123], v[184:187]
    buffer_load_dwordx4 v[92:95], v61, s[24:27], s75 offen sc1
    v_mfma_f32_16x16x32_bf16 v[184:187], a[24:27], v[116:119], v[184:187]
    v_mfma_f32_16x16x32_bf16 v[184:187], a[4:7], v[112:115], v[184:187]
    v_mfma_f32_16x16x32_bf16 v[188:191], a[8:11], v[112:115], 0
    ds_write_b64 v2, v[160:161] offset:0
    v_mfma_f32_16x16x32_bf16 v[188:191], a[28:31], v[116:119], v[188:191]
    v_mfma_f32_16x16x32_bf16 v[188:191], a[48:51], v[120:123], v[188:191]
    buffer_load_dwordx4 v[96:99], v62, s[24:27], s64 offen sc1
    ds_write_b64 v2, v[162:163] offset:512
    v_mfma_f32_16x16x32_bf16 v[188:191], a[68:71], v[124:127], v[188:191]
    v_mfma_f32_16x16x32_bf16 v[192:195], a[72:75], v[124:127], 0
    ds_write_b64 v2, v[164:165] offset:1024
    v_mfma_f32_16x16x32_bf16 v[192:195], a[52:55], v[120:123], v[192:195]
    v_mfma_f32_16x16x32_bf16 v[192:195], a[32:35], v[116:119], v[192:195]
    ds_write_b64 v2, v[166:167] offset:1536
    v_mfma_f32_16x16x32_bf16 v[192:195], a[12:15], v[112:115], v[192:195]
    buffer_load_dwordx4 v[100:103], v62, s[24:27], s65 offen sc1
    v_mfma_f32_16x16x32_bf16 v[196:199], a[16:19], v[112:115], 0
    ds_write_b64 v2, v[168:169] offset:2048
    v_mfma_f32_16x16x32_bf16 v[196:199], a[36:39], v[116:119], v[196:199]
    v_mfma_f32_16x16x32_bf16 v[196:199], a[56:59], v[120:123], v[196:199]
    ds_write_b64 v2, v[170:171] offset:2560
    v_mfma_f32_16x16x32_bf16 v[196:199], a[76:79], v[124:127], v[196:199]
    s_waitcnt vmcnt(6)
    v_mfma_f32_16x16x32_bf16 v[180:183], a[80:83], v[64:67], v[180:183]
    buffer_load_dwordx4 v[104:107], v62, s[24:27], s66 offen sc1
    ds_write_b64 v2, v[172:173] offset:3072
    v_mfma_f32_16x16x32_bf16 v[180:183], a[100:103], v[68:71], v[180:183]
    v_mfma_f32_16x16x32_bf16 v[180:183], a[120:123], v[72:75], v[180:183]
    ds_write_b64 v2, v[174:175] offset:3584
    v_mfma_f32_16x16x32_bf16 v[180:183], a[140:143], v[76:79], v[180:183]
    v_mfma_f32_16x16x32_bf16 v[184:187], a[144:147], v[76:79], v[184:187]
    ds_write_b64 v2, v[176:177] offset:4096
    v_mfma_f32_16x16x32_bf16 v[184:187], a[124:127], v[72:75], v[184:187]
    buffer_load_dwordx4 v[108:111], v62, s[24:27], s67 offen sc1
    v_mfma_f32_16x16x32_bf16 v[184:187], a[104:107], v[68:71], v[184:187]
    ds_write_b64 v2, v[178:179] offset:4608
    v_mfma_f32_16x16x32_bf16 v[184:187], a[84:87], v[64:67], v[184:187]
    v_mfma_f32_16x16x32_bf16 v[188:191], a[88:91], v[64:67], v[188:191]
    v_mfma_f32_16x16x32_bf16 v[188:191], a[108:111], v[68:71], v[188:191]
    v_mfma_f32_16x16x32_bf16 v[188:191], a[128:131], v[72:75], v[188:191]
    buffer_load_dwordx4 v[112:115], v62, s[24:27], s68 offen sc1
    v_mfma_f32_16x16x32_bf16 v[188:191], a[148:151], v[76:79], v[188:191]
    v_mfma_f32_16x16x32_bf16 v[192:195], a[152:155], v[76:79], v[192:195]
    v_mfma_f32_16x16x32_bf16 v[192:195], a[132:135], v[72:75], v[192:195]
    v_mfma_f32_16x16x32_bf16 v[192:195], a[112:115], v[68:71], v[192:195]
    v_mfma_f32_16x16x32_bf16 v[192:195], a[92:95], v[64:67], v[192:195]
    buffer_load_dwordx4 v[116:119], v62, s[24:27], s69 offen sc1
    v_mfma_f32_16x16x32_bf16 v[196:199], a[96:99], v[64:67], v[196:199]
    v_mfma_f32_16x16x32_bf16 v[196:199], a[116:119], v[68:71], v[196:199]
    v_mfma_f32_16x16x32_bf16 v[196:199], a[136:139], v[72:75], v[196:199]
    v_mfma_f32_16x16x32_bf16 v[196:199], a[156:159], v[76:79], v[196:199]
    s_waitcnt vmcnt(6)
    v_mfma_f32_16x16x32_bf16 v[180:183], a[160:163], v[80:83], v[180:183]
    buffer_load_dwordx4 v[120:123], v62, s[24:27], s70 offen sc1
    v_mfma_f32_16x16x32_bf16 v[180:183], a[180:183], v[84:87], v[180:183]
    v_mfma_f32_16x16x32_bf16 v[180:183], a[200:203], v[88:91], v[180:183]
    v_mfma_f32_16x16x32_bf16 v[180:183], a[220:223], v[92:95], v[180:183]
    v_mfma_f32_16x16x32_bf16 v[184:187], a[224:227], v[92:95], v[184:187]
    v_mfma_f32_16x16x32_bf16 v[184:187], a[204:207], v[88:91], v[184:187]
    buffer_load_dwordx4 v[124:127], v62, s[24:27], s71 offen sc1
    v_mfma_f32_16x16x32_bf16 v[184:187], a[184:187], v[84:87], v[184:187]
    s_waitcnt lgkmcnt(0)
    s_barrier
    v_mfma_f32_16x16x32_bf16 v[184:187], a[164:167], v[80:83], v[184:187]
    ds_read_b64 v[200:201], v3 offset:0
    v_mfma_f32_16x16x32_bf16 v[188:191], a[168:171], v[80:83], v[188:191]
    ds_read_b64 v[202:203], v3 offset:512
    v_mfma_f32_16x16x32_bf16 v[188:191], a[188:191], v[84:87], v[188:191]
    ds_read_b64 v[204:205], v3 offset:1024
    v_mfma_f32_16x16x32_bf16 v[188:191], a[208:211], v[88:91], v[188:191]
    buffer_load_dwordx4 v[64:67], v62, s[24:27], s72 offen sc1
    ds_read_b64 v[206:207], v3 offset:1536
    v_mfma_f32_16x16x32_bf16 v[188:191], a[228:231], v[92:95], v[188:191]
    ds_read_b64 v[208:209], v3 offset:2048
    v_mfma_f32_16x16x32_bf16 v[192:195], a[232:235], v[92:95], v[192:195]
    ds_read_b64 v[210:211], v3 offset:2560
    v_mfma_f32_16x16x32_bf16 v[192:195], a[212:215], v[88:91], v[192:195]
    ds_read_b64 v[212:213], v3 offset:3072
    v_mfma_f32_16x16x32_bf16 v[192:195], a[192:195], v[84:87], v[192:195]
    ds_read_b64 v[214:215], v3 offset:3584
    v_mfma_f32_16x16x32_bf16 v[192:195], a[172:175], v[80:83], v[192:195]
    buffer_load_dwordx4 v[68:71], v62, s[24:27], s73 offen sc1
    ds_read_b64 v[216:217], v3 offset:4096
    v_mfma_f32_16x16x32_bf16 v[196:199], a[176:179], v[80:83], v[196:199]
    ds_read_b64 v[218:219], v3 offset:4608
    v_mfma_f32_16x16x32_bf16 v[196:199], a[196:199], v[84:87], v[196:199]
    v_mfma_f32_16x16x32_bf16 v[196:199], a[216:219], v[88:91], v[196:199]
    v_mfma_f32_16x16x32_bf16 v[196:199], a[236:239], v[92:95], v[196:199]
    s_waitcnt vmcnt(6)
    v_mfma_f32_16x16x32_bf16 v[160:163], a[0:3], v[96:99], 0
    buffer_load_dwordx4 v[72:75], v62, s[24:27], s74 offen sc1
    v_mfma_f32_16x16x32_bf16 v[160:163], a[20:23], v[100:103], v[160:163]
    v_mfma_f32_16x16x32_bf16 v[160:163], a[40:43], v[104:107], v[160:163]
    v_mfma_f32_16x16x32_bf16 v[160:163], a[60:63], v[108:111], v[160:163]
    s_waitcnt lgkmcnt(0)
    v_mfma_f32_16x16x32_bf16 v[164:167], a[64:67], v[108:111], 0
    v_add_f32 v180, v180, v200
    v_mfma_f32_16x16x32_bf16 v[164:167], a[44:47], v[104:107], v[164:167]
    buffer_load_dwordx4 v[76:79], v62, s[24:27], s75 offen sc1
    v_add_f32 v181, v181, v201
    v_mfma_f32_16x16x32_bf16 v[164:167], a[24:27], v[100:103], v[164:167]
    v_add_f32 v182, v182, v202
    v_mfma_f32_16x16x32_bf16 v[164:167], a[4:7], v[96:99], v[164:167]
    v_add_f32 v183, v183, v203
    v_mfma_f32_16x16x32_bf16 v[168:171], a[8:11], v[96:99], 0
    v_add_f32 v184, v184, v204
    v_mfma_f32_16x16x32_bf16 v[168:171], a[28:31], v[100:103], v[168:171]
    v_add_f32 v185, v185, v205
    v_mfma_f32_16x16x32_bf16 v[168:171], a[48:51], v[104:107], v[168:171]
    buffer_load_dwordx4 v[80:83], v63, s[24:27], s64 offen sc1
    v_add_f32 v186, v186, v206
    v_mfma_f32_16x16x32_bf16 v[168:171], a[68:71], v[108:111], v[168:171]
    v_add_f32 v187, v187, v207
    v_mfma_f32_16x16x32_bf16 v[172:175], a[72:75], v[108:111], 0
    v_add_f32 v188, v188, v208
    v_mfma_f32_16x16x32_bf16 v[172:175], a[52:55], v[104:107], v[172:175]
    v_add_f32 v189, v189, v209
    v_mfma_f32_16x16x32_bf16 v[172:175], a[32:35], v[100:103], v[172:175]
    v_add_f32 v190, v190, v210
    v_mfma_f32_16x16x32_bf16 v[172:175], a[12:15], v[96:99], v[172:175]
    buffer_load_dwordx4 v[84:87], v63, s[24:27], s65 offen sc1
    v_add_f32 v191, v191, v211
    v_mfma_f32_16x16x32_bf16 v[176:179], a[16:19], v[96:99], 0
    v_add_f32 v192, v192, v212
    v_mfma_f32_16x16x32_bf16 v[176:179], a[36:39], v[100:103], v[176:179]
    v_add_f32 v193, v193, v213
    v_mfma_f32_16x16x32_bf16 v[176:179], a[56:59], v[104:107], v[176:179]
    v_add_f32 v194, v194, v214
    v_mfma_f32_16x16x32_bf16 v[176:179], a[76:79], v[108:111], v[176:179]
    v_add_f32 v195, v195, v215
    s_waitcnt vmcnt(6)
    v_mfma_f32_16x16x32_bf16 v[160:163], a[80:83], v[112:115], v[160:163]
    buffer_load_dwordx4 v[88:91], v63, s[24:27], s66 offen sc1
    v_add_f32 v196, v196, v216
    v_mfma_f32_16x16x32_bf16 v[160:163], a[100:103], v[116:119], v[160:163]
    v_add_f32 v197, v197, v217
    v_mfma_f32_16x16x32_bf16 v[160:163], a[120:123], v[120:123], v[160:163]
    v_add_f32 v198, v198, v218
    v_mfma_f32_16x16x32_bf16 v[160:163], a[140:143], v[124:127], v[160:163]
    v_add_f32 v199, v199, v219
    v_mfma_f32_16x16x32_bf16 v[164:167], a[144:147], v[124:127], v[164:167]
    ds_write_b64 v2, v[180:181] offset:5120
    v_mfma_f32_16x16x32_bf16 v[164:167], a[124:127], v[120:123], v[164:167]
    buffer_load_dwordx4 v[92:95], v63, s[24:27], s67 offen sc1
    v_mfma_f32_16x16x32_bf16 v[164:167], a[104:107], v[116:119], v[164:167]
    ds_write_b64 v2, v[182:183] offset:5632
    v_mfma_f32_16x16x32_bf16 v[164:167], a[84:87], v[112:115], v[164:167]
    v_mfma_f32_16x16x32_bf16 v[168:171], a[88:91], v[112:115], v[168:171]
    ds_write_b64 v2, v[184:185] offset:6144
    v_mfma_f32_16x16x32_bf16 v[168:171], a[108:111], v[116:119], v[168:171]
    v_mfma_f32_16x16x32_bf16 v[168:171], a[128:131], v[120:123], v[168:171]
    buffer_load_dwordx4 v[96:99], v63, s[24:27], s68 offen sc1
    ds_write_b64 v2, v[186:187] offset:6656
    v_mfma_f32_16x16x32_bf16 v[168:171], a[148:151], v[124:127], v[168:171]
    v_mfma_f32_16x16x32_bf16 v[172:175], a[152:155], v[124:127], v[172:175]
    ds_write_b64 v2, v[188:189] offset:7168
    v_mfma_f32_16x16x32_bf16 v[172:175], a[132:135], v[120:123], v[172:175]
    v_mfma_f32_16x16x32_bf16 v[172:175], a[112:115], v[116:119], v[172:175]
    ds_write_b64 v2, v[190:191] offset:7680
    v_mfma_f32_16x16x32_bf16 v[172:175], a[92:95], v[112:115], v[172:175]
    buffer_load_dwordx4 v[100:103], v63, s[24:27], s69 offen sc1
    v_mfma_f32_16x16x32_bf16 v[176:179], a[96:99], v[112:115], v[176:179]
    ds_write_b64 v2, v[192:193] offset:8192
    v_mfma_f32_16x16x32_bf16 v[176:179], a[116:119], v[116:119], v[176:179]
    v_mfma_f32_16x16x32_bf16 v[176:179], a[136:139], v[120:123], v[176:179]
    ds_write_b64 v2, v[194:195] offset:8704
    v_mfma_f32_16x16x32_bf16 v[176:179], a[156:159], v[124:127], v[176:179]
    s_waitcnt vmcnt(6)
    v_mfma_f32_16x16x32_bf16 v[160:163], a[160:163], v[64:67], v[160:163]
    buffer_load_dwordx4 v[104:107], v63, s[24:27], s70 offen sc1
    ds_write_b64 v2, v[196:197] offset:9216
    v_mfma_f32_16x16x32_bf16 v[160:163], a[180:183], v[68:71], v[160:163]
    v_mfma_f32_16x16x32_bf16 v[160:163], a[200:203], v[72:75], v[160:163]
    ds_write_b64 v2, v[198:199] offset:9728
    v_mfma_f32_16x16x32_bf16 v[160:163], a[220:223], v[76:79], v[160:163]
    v_mfma_f32_16x16x32_bf16 v[164:167], a[224:227], v[76:79], v[164:167]
    v_mfma_f32_16x16x32_bf16 v[164:167], a[204:207], v[72:75], v[164:167]
    buffer_load_dwordx4 v[108:111], v63, s[24:27], s71 offen sc1
    v_mfma_f32_16x16x32_bf16 v[164:167], a[184:187], v[68:71], v[164:167]
    s_waitcnt lgkmcnt(0)
    s_barrier
    v_mfma_f32_16x16x32_bf16 v[164:167], a[164:167], v[64:67], v[164:167]
    ds_read_b64 v[200:201], v3 offset:5120
    v_mfma_f32_16x16x32_bf16 v[168:171], a[168:171], v[64:67], v[168:171]
    ds_read_b64 v[202:203], v3 offset:5632
    v_mfma_f32_16x16x32_bf16 v[168:171], a[188:191], v[68:71], v[168:171]
    ds_read_b64 v[204:205], v3 offset:6144
    v_mfma_f32_16x16x32_bf16 v[168:171], a[208:211], v[72:75], v[168:171]
    buffer_load_dwordx4 v[112:115], v63, s[24:27], s72 offen sc1
    ds_read_b64 v[206:207], v3 offset:6656
    v_mfma_f32_16x16x32_bf16 v[168:171], a[228:231], v[76:79], v[168:171]
    ds_read_b64 v[208:209], v3 offset:7168
    v_mfma_f32_16x16x32_bf16 v[172:175], a[232:235], v[76:79], v[172:175]
    ds_read_b64 v[210:211], v3 offset:7680
    v_mfma_f32_16x16x32_bf16 v[172:175], a[212:215], v[72:75], v[172:175]
    ds_read_b64 v[212:213], v3 offset:8192
    v_mfma_f32_16x16x32_bf16 v[172:175], a[192:195], v[68:71], v[172:175]
    ds_read_b64 v[214:215], v3 offset:8704
    v_mfma_f32_16x16x32_bf16 v[172:175], a[172:175], v[64:67], v[172:175]
    buffer_load_dwordx4 v[116:119], v63, s[24:27], s73 offen sc1
    ds_read_b64 v[216:217], v3 offset:9216
    v_mfma_f32_16x16x32_bf16 v[176:179], a[176:179], v[64:67], v[176:179]
    ds_read_b64 v[218:219], v3 offset:9728
    v_mfma_f32_16x16x32_bf16 v[176:179], a[196:199], v[68:71], v[176:179]
    v_mfma_f32_16x16x32_bf16 v[176:179], a[216:219], v[72:75], v[176:179]
    v_mfma_f32_16x16x32_bf16 v[176:179], a[236:239], v[76:79], v[176:179]
    s_waitcnt vmcnt(6)
    v_mfma_f32_16x16x32_bf16 v[180:183], a[0:3], v[80:83], 0
    buffer_load_dwordx4 v[120:123], v63, s[24:27], s74 offen sc1
    v_mfma_f32_16x16x32_bf16 v[180:183], a[20:23], v[84:87], v[180:183]
    v_mfma_f32_16x16x32_bf16 v[180:183], a[40:43], v[88:91], v[180:183]
    v_mfma_f32_16x16x32_bf16 v[180:183], a[60:63], v[92:95], v[180:183]
    s_waitcnt lgkmcnt(0)
    v_mfma_f32_16x16x32_bf16 v[184:187], a[64:67], v[92:95], 0
    v_add_f32 v160, v160, v200
    v_mfma_f32_16x16x32_bf16 v[184:187], a[44:47], v[88:91], v[184:187]
    buffer_load_dwordx4 v[124:127], v63, s[24:27], s75 offen sc1
    v_add_f32 v161, v161, v201
    v_mfma_f32_16x16x32_bf16 v[184:187], a[24:27], v[84:87], v[184:187]
    v_add_f32 v162, v162, v202
    v_mfma_f32_16x16x32_bf16 v[184:187], a[4:7], v[80:83], v[184:187]
    v_add_f32 v163, v163, v203
    v_mfma_f32_16x16x32_bf16 v[188:191], a[8:11], v[80:83], 0
    v_add_f32 v164, v164, v204
    ds_write_b64 v2, v[160:161] offset:10240
    v_mfma_f32_16x16x32_bf16 v[188:191], a[28:31], v[84:87], v[188:191]
    v_add_f32 v165, v165, v205
    v_mfma_f32_16x16x32_bf16 v[188:191], a[48:51], v[88:91], v[188:191]
    v_add_f32 v166, v166, v206
    ds_write_b64 v2, v[162:163] offset:10752
    v_mfma_f32_16x16x32_bf16 v[188:191], a[68:71], v[92:95], v[188:191]
    v_add_f32 v167, v167, v207
    v_mfma_f32_16x16x32_bf16 v[192:195], a[72:75], v[92:95], 0
    v_add_f32 v168, v168, v208
    ds_write_b64 v2, v[164:165] offset:11264
    v_mfma_f32_16x16x32_bf16 v[192:195], a[52:55], v[88:91], v[192:195]
    v_add_f32 v169, v169, v209
    v_mfma_f32_16x16x32_bf16 v[192:195], a[32:35], v[84:87], v[192:195]
    v_add_f32 v170, v170, v210
    ds_write_b64 v2, v[166:167] offset:11776
    v_mfma_f32_16x16x32_bf16 v[192:195], a[12:15], v[80:83], v[192:195]
    v_add_f32 v171, v171, v211
    v_mfma_f32_16x16x32_bf16 v[196:199], a[16:19], v[80:83], 0
    v_add_f32 v172, v172, v212
    ds_write_b64 v2, v[168:169] offset:12288
    v_mfma_f32_16x16x32_bf16 v[196:199], a[36:39], v[84:87], v[196:199]
    v_add_f32 v173, v173, v213
    v_mfma_f32_16x16x32_bf16 v[196:199], a[56:59], v[88:91], v[196:199]
    v_add_f32 v174, v174, v214
    ds_write_b64 v2, v[170:171] offset:12800
    v_mfma_f32_16x16x32_bf16 v[196:199], a[76:79], v[92:95], v[196:199]
    v_add_f32 v175, v175, v215
    s_waitcnt vmcnt(4)
    v_mfma_f32_16x16x32_bf16 v[180:183], a[80:83], v[96:99], v[180:183]
    v_add_f32 v176, v176, v216
    ds_write_b64 v2, v[172:173] offset:13312
    v_mfma_f32_16x16x32_bf16 v[180:183], a[100:103], v[100:103], v[180:183]
    v_add_f32 v177, v177, v217
    v_mfma_f32_16x16x32_bf16 v[180:183], a[120:123], v[104:107], v[180:183]
    v_add_f32 v178, v178, v218
    ds_write_b64 v2, v[174:175] offset:13824
    v_mfma_f32_16x16x32_bf16 v[180:183], a[140:143], v[108:111], v[180:183]
    v_add_f32 v179, v179, v219
    v_mfma_f32_16x16x32_bf16 v[184:187], a[144:147], v[108:111], v[184:187]
    ds_write_b64 v2, v[176:177] offset:14336
    v_mfma_f32_16x16x32_bf16 v[184:187], a[124:127], v[104:107], v[184:187]
    v_mfma_f32_16x16x32_bf16 v[184:187], a[104:107], v[100:103], v[184:187]
    ds_write_b64 v2, v[178:179] offset:14848
    v_mfma_f32_16x16x32_bf16 v[184:187], a[84:87], v[96:99], v[184:187]
    v_mfma_f32_16x16x32_bf16 v[188:191], a[88:91], v[96:99], v[188:191]
    v_mfma_f32_16x16x32_bf16 v[188:191], a[108:111], v[100:103], v[188:191]
    v_mfma_f32_16x16x32_bf16 v[188:191], a[128:131], v[104:107], v[188:191]
    v_mfma_f32_16x16x32_bf16 v[188:191], a[148:151], v[108:111], v[188:191]
    s_waitcnt lgkmcnt(0)
    s_barrier
    v_mfma_f32_16x16x32_bf16 v[192:195], a[152:155], v[108:111], v[192:195]
    ds_read_b64 v[200:201], v3 offset:10240
    v_mfma_f32_16x16x32_bf16 v[192:195], a[132:135], v[104:107], v[192:195]
    ds_read_b64 v[202:203], v3 offset:10752
    v_mfma_f32_16x16x32_bf16 v[192:195], a[112:115], v[100:103], v[192:195]
    ds_read_b64 v[204:205], v3 offset:11264
    v_mfma_f32_16x16x32_bf16 v[192:195], a[92:95], v[96:99], v[192:195]
    ds_read_b64 v[206:207], v3 offset:11776
    v_mfma_f32_16x16x32_bf16 v[196:199], a[96:99], v[96:99], v[196:199]
    ds_read_b64 v[208:209], v3 offset:12288
    v_mfma_f32_16x16x32_bf16 v[196:199], a[116:119], v[100:103], v[196:199]
    ds_read_b64 v[210:211], v3 offset:12800
    v_mfma_f32_16x16x32_bf16 v[196:199], a[136:139], v[104:107], v[196:199]
    ds_read_b64 v[212:213], v3 offset:13312
    v_mfma_f32_16x16x32_bf16 v[196:199], a[156:159], v[108:111], v[196:199]
    ds_read_b64 v[214:215], v3 offset:13824
    s_waitcnt vmcnt(0)
    v_mfma_f32_16x16x32_bf16 v[180:183], a[160:163], v[112:115], v[180:183]
    ds_read_b64 v[216:217], v3 offset:14336
    v_mfma_f32_16x16x32_bf16 v[180:183], a[180:183], v[116:119], v[180:183]
    ds_read_b64 v[218:219], v3 offset:14848
    v_mfma_f32_16x16x32_bf16 v[180:183], a[200:203], v[120:123], v[180:183]
    v_mfma_f32_16x16x32_bf16 v[180:183], a[220:223], v[124:127], v[180:183]
    v_mfma_f32_16x16x32_bf16 v[184:187], a[224:227], v[124:127], v[184:187]
    v_mfma_f32_16x16x32_bf16 v[184:187], a[204:207], v[120:123], v[184:187]
    v_mfma_f32_16x16x32_bf16 v[184:187], a[184:187], v[116:119], v[184:187]
    v_mfma_f32_16x16x32_bf16 v[184:187], a[164:167], v[112:115], v[184:187]
    v_mfma_f32_16x16x32_bf16 v[188:191], a[168:171], v[112:115], v[188:191]
    v_mfma_f32_16x16x32_bf16 v[188:191], a[188:191], v[116:119], v[188:191]
    v_mfma_f32_16x16x32_bf16 v[188:191], a[208:211], v[120:123], v[188:191]
    s_waitcnt lgkmcnt(0)
    v_add_f32 v180, v180, v200
    v_mfma_f32_16x16x32_bf16 v[188:191], a[228:231], v[124:127], v[188:191]
    v_add_f32 v181, v181, v201
    v_add_f32 v182, v182, v202
    v_mfma_f32_16x16x32_bf16 v[192:195], a[232:235], v[124:127], v[192:195]
    v_add_f32 v183, v183, v203
    v_cvt_pk_bf16_f32 v144, v180, v181
    v_mfma_f32_16x16x32_bf16 v[192:195], a[212:215], v[120:123], v[192:195]
    v_cvt_pk_bf16_f32 v145, v182, v183
    v_add_f32 v184, v184, v204
    v_mfma_f32_16x16x32_bf16 v[192:195], a[192:195], v[116:119], v[192:195]
    v_add_f32 v185, v185, v205
    v_add_f32 v186, v186, v206
    v_mfma_f32_16x16x32_bf16 v[192:195], a[172:175], v[112:115], v[192:195]
    v_add_f32 v187, v187, v207
    v_cvt_pk_bf16_f32 v146, v184, v185
    v_mfma_f32_16x16x32_bf16 v[196:199], a[176:179], v[112:115], v[196:199]
    v_cvt_pk_bf16_f32 v147, v186, v187
    v_mfma_f32_16x16x32_bf16 v[196:199], a[196:199], v[116:119], v[196:199]
    v_add_f32 v188, v188, v208
    v_add_f32 v189, v189, v209
    v_mfma_f32_16x16x32_bf16 v[196:199], a[216:219], v[120:123], v[196:199]
    v_permlane16_swap_b32 v144, v146
    v_permlane16_swap_b32 v145, v147
    v_mfma_f32_16x16x32_bf16 v[196:199], a[236:239], v[124:127], v[196:199]
    buffer_store_dwordx4 v[144:147], v14, s[20:23], s56 offen offset:0
    v_add_f32 v190, v190, v210
    v_add_f32 v191, v191, v211
    v_cvt_pk_bf16_f32 v148, v188, v189
    v_cvt_pk_bf16_f32 v149, v190, v191
    v_add_f32 v192, v192, v212
    v_add_f32 v193, v193, v213
    v_add_f32 v194, v194, v214
    v_add_f32 v195, v195, v215
    v_cvt_pk_bf16_f32 v150, v192, v193
    v_cvt_pk_bf16_f32 v151, v194, v195
    v_add_f32 v196, v196, v216
    v_add_f32 v197, v197, v217
    v_permlane16_swap_b32 v148, v150
    v_permlane16_swap_b32 v149, v151
    buffer_store_dwordx4 v[148:151], v14, s[20:23], s56 offen offset:64
    v_add_f32 v198, v198, v218
    v_add_f32 v199, v199, v219
    v_cvt_pk_bf16_f32 v152, v196, v197
    v_cvt_pk_bf16_f32 v153, v198, v199
    buffer_store_dwordx2 v[152:153], v15, s[20:23], s56 offen offset:128
L_done:
    s_endpgm
L_zchk:
    s_mov_b32 s93, 0
L_zchk_1:
    buffer_load_dword v58, v8, s[28:31], 0 offen sc1
    s_add_u32 s93, s93, 1
    s_cmp_gt_u32 s93, 262144
    s_cbranch_scc1 L_zchk_ok
    s_waitcnt vmcnt(0)
    v_cmp_ne_u32 vcc, 1, v58
    s_cbranch_vccnz L_zchk_1
    s_branch L_zchk_ok
L_rchk:
    s_mov_b32 s93, 0
L_rchk_1:
    buffer_load_dword v58, v59, s[24:27], 0 offen sc1
    s_add_u32 s93, s93, 1
    s_cmp_gt_u32 s93, 262144
    s_cbranch_scc1 L_rchk_ok
    s_waitcnt vmcnt(0)
    v_cmp_ne_u32 vcc, 12, v58
    s_cbranch_vccnz L_rchk_1
    s_branch L_rchk_ok
L_poll:
    s_mov_b32 s93, 0
L_poll_1:
    buffer_load_dword v3, v2, s[24:27], s58 offen sc1
    s_add_u32 s93, s93, 1
    s_cmp_gt_u32 s93, 262144
    s_cbranch_scc1 L_poll_ok
    s_waitcnt vmcnt(0)
    v_cmp_ne_u32 vcc, 4, v3
    s_cbranch_vccnz L_poll_1
    s_branch L_poll_ok
L_end:
.section .rodata,"a"
.p2align 6
.amdhsa_kernel standalone__glu_gated_reglu__prompt_kernel
  .amdhsa_next_free_vgpr 496
  .amdhsa_next_free_sgpr 100
  .amdhsa_accum_offset 256
  .amdhsa_group_segment_fixed_size 0
  .amdhsa_float_denorm_mode_32 3
  .amdhsa_kernarg_size 56
  .amdhsa_user_sgpr_count 2
  .amdhsa_user_sgpr_kernarg_segment_ptr 1
  .amdhsa_system_sgpr_workgroup_id_x 1
.end_amdhsa_kernel
```
